```python
import torch

def _softmax(x, axis=-1):
    return torch.softmax(x, dim=axis)
def _gelu(x):
    return torch.nn.functional.gelu(x, approximate="tanh")
def _silu(x):
    return torch.nn.functional.silu(x)
def _sigmoid(x):
    return torch.sigmoid(x)
def _layernorm(x, axis=-1, eps=1e-5):
    m = x.mean(dim=axis, keepdim=True)
    v = x.var(dim=axis, keepdim=True, unbiased=False)
    return (x - m) / torch.sqrt(v + eps)
def _scatter_add(tgt, idx, src, axis=0):
    return tgt.clone().index_add_(axis, idx, src)
def _segment_sum(src, seg, n):
    out = torch.zeros((n,) + src.shape[1:], dtype=src.dtype)
    return out.index_add_(0, seg, src)
def _pad(x, pw):
    flat = tuple(v for pair in reversed(pw) for v in pair)
    return torch.nn.functional.pad(x, flat)

kernel_name = 'parallel_sum__gqa_block_cached__geglu_ffn__decode'

def setup_inputs():

    _w = (lambda a: (lambda t: t.to(torch.bfloat16) if t.is_floating_point() else t)(torch.as_tensor(a)))
    def _A_setup():
        B, Sq, D = 2, 1, 576
        Hq, Hkv, Sk, Dh = 32, 16, 32768, 128
        assert Hq % Hkv == 0, (Hq, Hkv)
        return {
            "x": _w((lambda *s: torch.randn(*s, dtype=torch.bfloat16) * 0.05)(B, Sq, D)),
            "k_cache": _w((lambda *s: torch.randn(*s, dtype=torch.bfloat16) * 3.2)(B, Hkv, Sk, Dh)),
            "v_cache": _w((lambda *s: torch.randn(*s, dtype=torch.bfloat16) * 1.6)(B, Hkv, Sk, Dh)),
            "wq": _w((lambda *s: torch.randn(*s, dtype=torch.bfloat16) * 3.2)(D, Hq * Dh) * (D ** -0.5)),
            "wo": _w((lambda *s: torch.randn(*s, dtype=torch.bfloat16) * 1.6)(Hq * Dh, D) * ((Hq * Dh) ** -0.5)),
        }
    _A_in = _A_setup()

    def _B_setup():
        B, S, D, F = 2, 1, 576, 4608
        return {
            "x": _w((lambda *s: torch.randn(*s, dtype=torch.bfloat16) * 0.05)(B, S, D)),
            "w_gate": _w((lambda *s: torch.randn(*s, dtype=torch.bfloat16) * 0.05)(D, F)),
            "w_up": _w((lambda *s: torch.randn(*s, dtype=torch.bfloat16) * 0.05)(D, F)),
            "w_down": _w((lambda *s: torch.randn(*s, dtype=torch.bfloat16) * 0.05)(F, D)),
        }
    _B_in = _B_setup()

    return {
        "A_x": _A_in["x"],
        "A_k_cache": _A_in["k_cache"],
        "A_v_cache": _A_in["v_cache"],
        "A_wq": _A_in["wq"],
        "A_wo": _A_in["wo"],
        "B_x": _B_in["x"],
        "B_w_gate": _B_in["w_gate"],
        "B_w_up": _B_in["w_up"],
        "B_w_down": _B_in["w_down"],
    }

def reference(A_x, A_k_cache, A_v_cache, A_wq, A_wo, B_x, B_w_gate, B_w_up, B_w_down):
    def _A_ref(x, k_cache, v_cache, wq, wo):
        B, Sq, D = x.shape
        Hq, Dh = 32, 128
        Hkv = k_cache.shape[1]
        rep = Hq // Hkv
        q = (lambda x, *d: x.permute(*d))((x @ wq).reshape(B, Sq, Hq, Dh), 0, 2, 1, 3)
        k = (lambda x, n, axis: torch.repeat_interleave(x, n, dim=axis))(k_cache, rep, axis=1)
        v = (lambda x, n, axis: torch.repeat_interleave(x, n, dim=axis))(v_cache, rep, axis=1)
        scores = torch.einsum("bhqd,bhkd->bhqk", q, k) * (Dh ** -0.5)
        p = _softmax(scores, axis=-1)
        o = torch.einsum("bhqk,bhkd->bhqd", p, v)
        return (lambda x, *d: x.permute(*d))(o, 0, 2, 1, 3).reshape(B, Sq, Hq * Dh) @ wo

    def _B_ref(x, w_gate, w_up, w_down):
        return (_gelu(x @ w_gate) * (x @ w_up)) @ w_down

    x = A_x
    xn = _layernorm(x, axis=-1)
    return x + _A_ref(xn, A_k_cache, A_v_cache, A_wq, A_wo) + _B_ref(xn, B_w_gate, B_w_up, B_w_down)
```

```asm
; @launch grid=(256,1,1) block=(384,1,1) lds=41984
.amdgcn_target "amdgcn-amd-amdhsa--gfx950"
.text
.globl parallel_sum__gqa_block_cached__geglu_ffn__decode_kernel
.p2align 8
.type parallel_sum__gqa_block_cached__geglu_ffn__decode_kernel,@function
parallel_sum__gqa_block_cached__geglu_ffn__decode_kernel:
s_cmp_ge_u32 s2, 256
s_cbranch_scc1 L_end
s_load_dwordx16 s[16:31], s[0:1], 0
s_load_dwordx8 s[32:39], s[0:1], 64
v_lshrrev_b32 v1, 6, v0
s_nop 0
v_readfirstlane_b32 s3, v1
v_and_b32 v0, 63, v0
s_waitcnt lgkmcnt(0)
s_mov_b32 s40, s38
s_and_b32 s41, s39, 0xffff
s_mov_b32 s42, 1048576
s_mov_b32 s43, 0x20000
s_cmp_eq_u32 s3, 4
s_cbranch_scc1 L_auxq
s_cmp_eq_u32 s3, 5
s_cbranch_scc1 L_auxf
s_mov_b32 s44, s18
s_and_b32 s45, s19, 0xffff
s_mov_b32 s46, 268435456
s_mov_b32 s47, 0x20000
s_mov_b32 s48, s20
s_and_b32 s49, s21, 0xffff
s_mov_b32 s50, 268435456
s_mov_b32 s51, 0x20000
s_lshr_b32 s58, s2, 3
s_lshl_b32 s52, s58, 23
s_and_b32 s58, s2, 7
s_lshl_b32 s58, s58, 2
s_add_u32 s54, s58, s3
s_add_u32 s55, s54, 32
s_mov_b32 s56, 0
v_bfe_u32 v12, v0, 2, 2
v_lshlrev_b32 v12, 8, v12
v_lshrrev_b32 v13, 4, v0
v_lshl_add_u32 v12, v13, 6, v12
v_and_b32 v13, 3, v0
v_lshl_add_u32 v12, v13, 4, v12
v_lshlrev_b32 v13, 4, v0
v_add_u32 v2, 0, v12
v_add_u32 v4, 0, v13
v_add_u32 v3, 4096, v12
v_add_u32 v5, 4096, v13
s_lshr_b32 s58, s54, 5
s_and_b32 s59, s54, 31
s_lshr_b32 s60, s59, 2
s_and_b32 s59, s59, 3
s_lshl_b32 s58, s58, 1
s_and_b32 s67, s60, 1
s_add_u32 s58, s58, s67
s_lshr_b32 s60, s60, 1
s_mul_i32 s60, s60, 256
s_lshl_b32 s58, s58, 2
s_add_u32 s60, s60, s58
s_mul_i32 s57, s60, 8192
s_lshl_b32 s59, s59, 10
s_add_u32 s57, s57, s59
s_add_u32 s57, s57, s52
s_add_u32 s69, s57, 4096
s_add_u32 s70, s57, 8192
s_add_u32 s71, s57, 12288
s_add_u32 s72, s57, 16384
s_add_u32 s73, s57, 20480
s_add_u32 s74, s57, 24576
s_add_u32 s75, s57, 28672
buffer_load_dwordx4 v[140:143], v2, s[44:47], s57 offen nt
buffer_load_dwordx4 v[144:147], v2, s[44:47], s69 offen nt
buffer_load_dwordx4 v[148:151], v2, s[44:47], s70 offen nt
buffer_load_dwordx4 v[152:155], v2, s[44:47], s71 offen nt
s_barrier
buffer_load_dwordx4 v[156:159], v2, s[44:47], s72 offen nt
buffer_load_dwordx4 v[160:163], v2, s[44:47], s73 offen nt
buffer_load_dwordx4 v[164:167], v2, s[44:47], s74 offen nt
buffer_load_dwordx4 v[168:171], v2, s[44:47], s75 offen nt
buffer_load_dwordx4 v[172:175], v4, s[48:51], s57 offen nt
buffer_load_dwordx4 v[176:179], v4, s[48:51], s69 offen nt
buffer_load_dwordx4 v[180:183], v4, s[48:51], s70 offen nt
buffer_load_dwordx4 v[184:187], v4, s[48:51], s71 offen nt
s_mov_b32 s61, 0x3fb8aa3b
s_mov_b32 s62, 0x3db504f3
s_mov_b32 s64, 0x00ff00ff
s_mov_b32 s65, 0xff00ff00
v_mov_b32 v6, 0
v_mov_b32 v15, 1
v_mov_b32 v24, 0
v_mov_b32 v25, 0
v_mov_b32 v26, 0
v_mov_b32 v27, 0
v_mov_b32 v8, 0xff7fffff
v_mov_b32 v9, 0
v_mov_b32 v10, 0
v_and_b32 v12, 1, v0
v_cmp_eq_u32 vcc, 1, v12
v_mov_b32 v13, 0xffff0000
v_mov_b32 v14, 0xffff
v_cndmask_b32 v13, v14, v13, vcc
v_bfe_u32 v12, v0, 1, 2
v_cmp_eq_u32 vcc, 0, v12
s_nop 1
v_cndmask_b32 v20, v6, v13, vcc
v_cmp_eq_u32 vcc, 1, v12
s_nop 1
v_cndmask_b32 v21, v6, v13, vcc
v_cmp_eq_u32 vcc, 2, v12
s_nop 1
v_cndmask_b32 v22, v6, v13, vcc
v_cmp_eq_u32 vcc, 3, v12
s_nop 1
v_cndmask_b32 v23, v6, v13, vcc
v_bfe_u32 v11, v0, 3, 1
v_lshlrev_b32 v11, 8, v11
v_lshrrev_b32 v13, 4, v0
v_lshl_add_u32 v11, v13, 6, v11
v_and_b32 v13, 3, v0
v_lshl_add_u32 v11, v13, 4, v11
s_waitcnt vmcnt(11)
buffer_load_dwordx4 v[188:191], v4, s[48:51], s72 offen nt
s_waitcnt vmcnt(11)
buffer_load_dwordx4 v[192:195], v4, s[48:51], s73 offen nt
s_waitcnt vmcnt(11)
buffer_load_dwordx4 v[196:199], v4, s[48:51], s74 offen nt
s_waitcnt vmcnt(11)
buffer_load_dwordx4 v[200:203], v4, s[48:51], s75 offen nt
s_mov_b32 s54, s55
s_add_u32 s55, s55, 32
s_mov_b32 s56, 1
s_lshr_b32 s58, s54, 5
s_and_b32 s59, s54, 31
s_lshr_b32 s60, s59, 2
s_and_b32 s59, s59, 3
s_lshl_b32 s58, s58, 1
s_and_b32 s67, s60, 1
s_add_u32 s58, s58, s67
s_lshr_b32 s60, s60, 1
s_mul_i32 s60, s60, 256
s_lshl_b32 s58, s58, 2
s_add_u32 s60, s60, s58
s_mul_i32 s57, s60, 8192
s_lshl_b32 s59, s59, 10
s_add_u32 s57, s57, s59
s_add_u32 s57, s57, s52
s_add_u32 s69, s57, 4096
s_add_u32 s70, s57, 8192
s_add_u32 s71, s57, 12288
s_add_u32 s72, s57, 16384
s_add_u32 s73, s57, 20480
s_add_u32 s74, s57, 24576
s_add_u32 s75, s57, 28672
s_waitcnt vmcnt(11)
buffer_load_dwordx4 v[76:79], v2, s[44:47], s57 offen nt
s_waitcnt vmcnt(11)
buffer_load_dwordx4 v[80:83], v2, s[44:47], s69 offen nt
s_waitcnt vmcnt(11)
buffer_load_dwordx4 v[84:87], v2, s[44:47], s70 offen nt
s_waitcnt vmcnt(11)
buffer_load_dwordx4 v[88:91], v2, s[44:47], s71 offen nt
s_waitcnt vmcnt(11)
buffer_load_dwordx4 v[92:95], v2, s[44:47], s72 offen nt
s_waitcnt vmcnt(11)
buffer_load_dwordx4 v[96:99], v2, s[44:47], s73 offen nt
s_waitcnt vmcnt(11)
buffer_load_dwordx4 v[100:103], v2, s[44:47], s74 offen nt
s_waitcnt vmcnt(11)
buffer_load_dwordx4 v[104:107], v2, s[44:47], s75 offen nt
s_waitcnt vmcnt(11)
buffer_load_dwordx4 v[108:111], v4, s[48:51], s57 offen nt
s_waitcnt vmcnt(11)
buffer_load_dwordx4 v[112:115], v4, s[48:51], s69 offen nt
s_waitcnt vmcnt(11)
buffer_load_dwordx4 v[116:119], v4, s[48:51], s70 offen nt
s_waitcnt vmcnt(11)
buffer_load_dwordx4 v[120:123], v4, s[48:51], s71 offen nt
s_waitcnt vmcnt(11)
buffer_load_dwordx4 v[124:127], v4, s[48:51], s72 offen nt
s_waitcnt vmcnt(11)
buffer_load_dwordx4 v[128:131], v4, s[48:51], s73 offen nt
s_waitcnt vmcnt(11)
buffer_load_dwordx4 v[132:135], v4, s[48:51], s74 offen nt
s_waitcnt vmcnt(11)
buffer_load_dwordx4 v[136:139], v4, s[48:51], s75 offen nt
s_mov_b32 s58, 8000000
L_ld_1:
ds_read_b32 v12, v6 offset:9036
s_waitcnt lgkmcnt(0)
v_cmp_ne_u32 vcc, 1, v12
s_nop 3
s_cbranch_vccz L_ldd_2
s_sleep 1
s_sub_u32 s58, s58, 1
s_cmp_lg_u32 s58, 0
s_cbranch_scc1 L_ld_1
L_ldd_2:
ds_read_b128 v[16:19], v11 offset:2304
s_waitcnt lgkmcnt(0)
s_waitcnt vmcnt(31)
v_mfma_f32_16x16x32_bf16 v[44:47], v[140:143], v[16:19], 0
s_waitcnt vmcnt(30)
v_mfma_f32_16x16x32_bf16 v[48:51], v[144:147], v[16:19], 0
s_waitcnt vmcnt(29)
v_mfma_f32_16x16x32_bf16 v[52:55], v[148:151], v[16:19], 0
s_waitcnt vmcnt(28)
v_mfma_f32_16x16x32_bf16 v[56:59], v[152:155], v[16:19], 0
s_waitcnt vmcnt(27)
v_mfma_f32_16x16x32_bf16 v[60:63], v[156:159], v[16:19], 0
s_waitcnt vmcnt(26)
v_mfma_f32_16x16x32_bf16 v[64:67], v[160:163], v[16:19], 0
s_waitcnt vmcnt(25)
v_mfma_f32_16x16x32_bf16 v[68:71], v[164:167], v[16:19], 0
s_waitcnt vmcnt(24)
v_mfma_f32_16x16x32_bf16 v[72:75], v[168:171], v[16:19], 0
v_mov_b32_dpp v36, v44 quad_perm:[0,0,0,0] row_mask:0xf bank_mask:0xf
v_add_f32_dpp v36, v45, v36 quad_perm:[1,1,1,1] row_mask:0xf bank_mask:0xf
v_add_f32_dpp v36, v46, v36 quad_perm:[2,2,2,2] row_mask:0xf bank_mask:0xf
v_add_f32_dpp v36, v47, v36 quad_perm:[3,3,3,3] row_mask:0xf bank_mask:0xf
v_mov_b32_dpp v37, v48 quad_perm:[0,0,0,0] row_mask:0xf bank_mask:0xf
v_add_f32_dpp v37, v49, v37 quad_perm:[1,1,1,1] row_mask:0xf bank_mask:0xf
v_add_f32_dpp v37, v50, v37 quad_perm:[2,2,2,2] row_mask:0xf bank_mask:0xf
v_add_f32_dpp v37, v51, v37 quad_perm:[3,3,3,3] row_mask:0xf bank_mask:0xf
v_cvt_pk_bf16_f32 v12, v36, v37
v_lshlrev_b32 v36, 16, v12
v_and_b32 v37, 0xffff0000, v12
v_mul_f32 v36, s62, v36
v_mul_f32 v37, s62, v37
v_cvt_pk_bf16_f32 v12, v36, v37
v_lshlrev_b32 v36, 16, v12
v_and_b32 v37, 0xffff0000, v12
v_mov_b32_dpp v38, v52 quad_perm:[0,0,0,0] row_mask:0xf bank_mask:0xf
v_add_f32_dpp v38, v53, v38 quad_perm:[1,1,1,1] row_mask:0xf bank_mask:0xf
v_add_f32_dpp v38, v54, v38 quad_perm:[2,2,2,2] row_mask:0xf bank_mask:0xf
v_add_f32_dpp v38, v55, v38 quad_perm:[3,3,3,3] row_mask:0xf bank_mask:0xf
v_mov_b32_dpp v39, v56 quad_perm:[0,0,0,0] row_mask:0xf bank_mask:0xf
v_add_f32_dpp v39, v57, v39 quad_perm:[1,1,1,1] row_mask:0xf bank_mask:0xf
v_add_f32_dpp v39, v58, v39 quad_perm:[2,2,2,2] row_mask:0xf bank_mask:0xf
v_add_f32_dpp v39, v59, v39 quad_perm:[3,3,3,3] row_mask:0xf bank_mask:0xf
v_cvt_pk_bf16_f32 v12, v38, v39
v_lshlrev_b32 v38, 16, v12
v_and_b32 v39, 0xffff0000, v12
v_mul_f32 v38, s62, v38
v_mul_f32 v39, s62, v39
v_cvt_pk_bf16_f32 v12, v38, v39
v_lshlrev_b32 v38, 16, v12
v_and_b32 v39, 0xffff0000, v12
v_mov_b32_dpp v40, v60 quad_perm:[0,0,0,0] row_mask:0xf bank_mask:0xf
v_add_f32_dpp v40, v61, v40 quad_perm:[1,1,1,1] row_mask:0xf bank_mask:0xf
v_add_f32_dpp v40, v62, v40 quad_perm:[2,2,2,2] row_mask:0xf bank_mask:0xf
v_add_f32_dpp v40, v63, v40 quad_perm:[3,3,3,3] row_mask:0xf bank_mask:0xf
v_mov_b32_dpp v41, v64 quad_perm:[0,0,0,0] row_mask:0xf bank_mask:0xf
v_add_f32_dpp v41, v65, v41 quad_perm:[1,1,1,1] row_mask:0xf bank_mask:0xf
v_add_f32_dpp v41, v66, v41 quad_perm:[2,2,2,2] row_mask:0xf bank_mask:0xf
v_add_f32_dpp v41, v67, v41 quad_perm:[3,3,3,3] row_mask:0xf bank_mask:0xf
v_cvt_pk_bf16_f32 v12, v40, v41
v_lshlrev_b32 v40, 16, v12
v_and_b32 v41, 0xffff0000, v12
v_mul_f32 v40, s62, v40
v_mul_f32 v41, s62, v41
v_cvt_pk_bf16_f32 v12, v40, v41
v_lshlrev_b32 v40, 16, v12
v_and_b32 v41, 0xffff0000, v12
v_mov_b32_dpp v42, v68 quad_perm:[0,0,0,0] row_mask:0xf bank_mask:0xf
v_add_f32_dpp v42, v69, v42 quad_perm:[1,1,1,1] row_mask:0xf bank_mask:0xf
v_add_f32_dpp v42, v70, v42 quad_perm:[2,2,2,2] row_mask:0xf bank_mask:0xf
v_add_f32_dpp v42, v71, v42 quad_perm:[3,3,3,3] row_mask:0xf bank_mask:0xf
v_mov_b32_dpp v43, v72 quad_perm:[0,0,0,0] row_mask:0xf bank_mask:0xf
v_add_f32_dpp v43, v73, v43 quad_perm:[1,1,1,1] row_mask:0xf bank_mask:0xf
v_add_f32_dpp v43, v74, v43 quad_perm:[2,2,2,2] row_mask:0xf bank_mask:0xf
v_add_f32_dpp v43, v75, v43 quad_perm:[3,3,3,3] row_mask:0xf bank_mask:0xf
v_cvt_pk_bf16_f32 v12, v42, v43
v_lshlrev_b32 v42, 16, v12
v_and_b32 v43, 0xffff0000, v12
v_mul_f32 v42, s62, v42
v_mul_f32 v43, s62, v43
v_cvt_pk_bf16_f32 v12, v42, v43
v_lshlrev_b32 v42, 16, v12
v_and_b32 v43, 0xffff0000, v12
v_max3_f32 v11, v36, v37, v38
v_max3_f32 v11, v11, v39, v40
v_max3_f32 v11, v11, v41, v42
v_max_f32 v11, v11, v43
v_cmp_gt_f32 vcc, v11, v8
s_nop 3
s_cbranch_vccz L_norescale_3
v_mov_b32 v12, v11
s_nop 1
v_permlane16_swap_b32 v12, v11
v_max_f32 v11, v11, v12
v_mov_b32 v12, v11
s_nop 1
v_permlane32_swap_b32 v12, v11
v_max_f32 v11, v11, v12
v_max_f32 v11, v11, v8
v_sub_f32 v12, v8, v11
v_mul_f32 v12, s61, v12
v_exp_f32 v12, v12
v_mov_b32 v8, v11
v_mul_f32 v10, s61, v11
v_sub_f32 v10, 0, v10
v_mul_f32 v9, v9, v12
v_mov_b32_dpp v13, v12 row_ror:8 row_mask:0xf bank_mask:0xf
v_cndmask_b32 v13, v13, v12, s[64:65]
v_mul_f32 v24, v24, v13
v_mul_f32 v25, v25, v13
v_mul_f32 v26, v26, v13
v_mul_f32 v27, v27, v13
s_nop 1
L_norescale_3:
v_fma_f32 v36, v36, s61, v10
v_fma_f32 v37, v37, s61, v10
v_fma_f32 v38, v38, s61, v10
v_fma_f32 v39, v39, s61, v10
v_fma_f32 v40, v40, s61, v10
v_fma_f32 v41, v41, s61, v10
v_fma_f32 v42, v42, s61, v10
v_fma_f32 v43, v43, s61, v10
v_exp_f32 v36, v36
v_exp_f32 v37, v37
v_exp_f32 v38, v38
v_exp_f32 v39, v39
v_exp_f32 v40, v40
v_exp_f32 v41, v41
v_exp_f32 v42, v42
v_exp_f32 v43, v43
v_add_f32 v9, v9, v36
v_cvt_pk_bf16_f32 v36, v36, v36
v_add_f32 v9, v9, v37
v_cvt_pk_bf16_f32 v37, v37, v37
v_add_f32 v9, v9, v38
v_cvt_pk_bf16_f32 v38, v38, v38
v_add_f32 v9, v9, v39
v_cvt_pk_bf16_f32 v39, v39, v39
v_add_f32 v9, v9, v40
v_cvt_pk_bf16_f32 v40, v40, v40
v_add_f32 v9, v9, v41
v_cvt_pk_bf16_f32 v41, v41, v41
v_add_f32 v9, v9, v42
v_cvt_pk_bf16_f32 v42, v42, v42
v_add_f32 v9, v9, v43
v_cvt_pk_bf16_f32 v43, v43, v43
v_and_b32 v28, v20, v36
v_and_b32 v29, v21, v36
v_and_b32 v30, v22, v36
v_and_b32 v31, v23, v36
v_and_b32 v32, v20, v37
v_and_b32 v33, v21, v37
v_and_b32 v34, v22, v37
v_and_b32 v35, v23, v37
s_waitcnt vmcnt(23)
v_mfma_f32_16x16x32_bf16 v[24:27], v[28:31], v[172:175], v[24:27]
v_and_b32 v28, v20, v38
v_and_b32 v29, v21, v38
v_and_b32 v30, v22, v38
v_and_b32 v31, v23, v38
s_waitcnt vmcnt(22)
v_mfma_f32_16x16x32_bf16 v[24:27], v[32:35], v[176:179], v[24:27]
v_and_b32 v32, v20, v39
v_and_b32 v33, v21, v39
v_and_b32 v34, v22, v39
v_and_b32 v35, v23, v39
s_waitcnt vmcnt(21)
v_mfma_f32_16x16x32_bf16 v[24:27], v[28:31], v[180:183], v[24:27]
v_and_b32 v28, v20, v40
v_and_b32 v29, v21, v40
v_and_b32 v30, v22, v40
v_and_b32 v31, v23, v40
s_waitcnt vmcnt(20)
v_mfma_f32_16x16x32_bf16 v[24:27], v[32:35], v[184:187], v[24:27]
v_and_b32 v32, v20, v41
v_and_b32 v33, v21, v41
v_and_b32 v34, v22, v41
v_and_b32 v35, v23, v41
s_waitcnt vmcnt(19)
v_mfma_f32_16x16x32_bf16 v[24:27], v[28:31], v[188:191], v[24:27]
v_and_b32 v28, v20, v42
v_and_b32 v29, v21, v42
v_and_b32 v30, v22, v42
v_and_b32 v31, v23, v42
s_waitcnt vmcnt(18)
v_mfma_f32_16x16x32_bf16 v[24:27], v[32:35], v[192:195], v[24:27]
v_and_b32 v32, v20, v43
v_and_b32 v33, v21, v43
v_and_b32 v34, v22, v43
v_and_b32 v35, v23, v43
s_waitcnt vmcnt(17)
v_mfma_f32_16x16x32_bf16 v[24:27], v[28:31], v[196:199], v[24:27]
s_waitcnt vmcnt(16)
v_mfma_f32_16x16x32_bf16 v[24:27], v[32:35], v[200:203], v[24:27]
s_nop 7
L_loop:
s_cmp_lt_u32 s56, 25
s_cbranch_scc1 L_noclaim
s_mov_b64 exec, 1
ds_add_rtn_u32 v7, v6, v15 offset:9040
s_mov_b64 exec, -1
L_noclaim:
s_lshr_b32 s58, s55, 5
s_and_b32 s59, s55, 31
s_lshr_b32 s60, s59, 2
s_and_b32 s59, s59, 3
s_lshl_b32 s58, s58, 1
s_and_b32 s67, s60, 1
s_add_u32 s58, s58, s67
s_lshr_b32 s60, s60, 1
s_mul_i32 s60, s60, 256
s_lshl_b32 s58, s58, 2
s_add_u32 s60, s60, s58
s_mul_i32 s57, s60, 8192
s_lshl_b32 s59, s59, 10
s_add_u32 s57, s57, s59
s_add_u32 s57, s57, s52
s_cmp_lt_u32 s55, 1024
s_cselect_b32 s57, s57, 0x80000000
s_add_u32 s69, s57, 4096
s_add_u32 s70, s57, 8192
s_add_u32 s71, s57, 12288
s_add_u32 s72, s57, 16384
s_add_u32 s73, s57, 20480
s_add_u32 s74, s57, 24576
s_add_u32 s75, s57, 28672
s_waitcnt vmcnt(15)
v_mfma_f32_16x16x32_bf16 v[44:47], v[76:79], v[16:19], 0
buffer_load_dwordx4 v[76:79], v2, s[44:47], s57 offen nt
s_waitcnt vmcnt(15)
v_mfma_f32_16x16x32_bf16 v[48:51], v[80:83], v[16:19], 0
buffer_load_dwordx4 v[80:83], v2, s[44:47], s69 offen nt
s_waitcnt vmcnt(15)
v_mfma_f32_16x16x32_bf16 v[52:55], v[84:87], v[16:19], 0
buffer_load_dwordx4 v[84:87], v2, s[44:47], s70 offen nt
s_waitcnt vmcnt(15)
v_mfma_f32_16x16x32_bf16 v[56:59], v[88:91], v[16:19], 0
buffer_load_dwordx4 v[88:91], v2, s[44:47], s71 offen nt
s_waitcnt vmcnt(15)
v_mfma_f32_16x16x32_bf16 v[60:63], v[92:95], v[16:19], 0
buffer_load_dwordx4 v[92:95], v2, s[44:47], s72 offen nt
s_waitcnt vmcnt(15)
v_mfma_f32_16x16x32_bf16 v[64:67], v[96:99], v[16:19], 0
buffer_load_dwordx4 v[96:99], v2, s[44:47], s73 offen nt
s_waitcnt vmcnt(15)
v_mfma_f32_16x16x32_bf16 v[68:71], v[100:103], v[16:19], 0
buffer_load_dwordx4 v[100:103], v2, s[44:47], s74 offen nt
s_waitcnt vmcnt(15)
v_mfma_f32_16x16x32_bf16 v[72:75], v[104:107], v[16:19], 0
buffer_load_dwordx4 v[104:107], v2, s[44:47], s75 offen nt
v_mov_b32_dpp v36, v44 quad_perm:[0,0,0,0] row_mask:0xf bank_mask:0xf
v_add_f32_dpp v36, v45, v36 quad_perm:[1,1,1,1] row_mask:0xf bank_mask:0xf
v_add_f32_dpp v36, v46, v36 quad_perm:[2,2,2,2] row_mask:0xf bank_mask:0xf
v_add_f32_dpp v36, v47, v36 quad_perm:[3,3,3,3] row_mask:0xf bank_mask:0xf
v_mov_b32_dpp v37, v48 quad_perm:[0,0,0,0] row_mask:0xf bank_mask:0xf
v_add_f32_dpp v37, v49, v37 quad_perm:[1,1,1,1] row_mask:0xf bank_mask:0xf
v_add_f32_dpp v37, v50, v37 quad_perm:[2,2,2,2] row_mask:0xf bank_mask:0xf
v_add_f32_dpp v37, v51, v37 quad_perm:[3,3,3,3] row_mask:0xf bank_mask:0xf
v_cvt_pk_bf16_f32 v12, v36, v37
v_lshlrev_b32 v36, 16, v12
v_and_b32 v37, 0xffff0000, v12
v_mul_f32 v36, s62, v36
v_mul_f32 v37, s62, v37
v_cvt_pk_bf16_f32 v12, v36, v37
v_lshlrev_b32 v36, 16, v12
v_and_b32 v37, 0xffff0000, v12
v_mov_b32_dpp v38, v52 quad_perm:[0,0,0,0] row_mask:0xf bank_mask:0xf
v_add_f32_dpp v38, v53, v38 quad_perm:[1,1,1,1] row_mask:0xf bank_mask:0xf
v_add_f32_dpp v38, v54, v38 quad_perm:[2,2,2,2] row_mask:0xf bank_mask:0xf
v_add_f32_dpp v38, v55, v38 quad_perm:[3,3,3,3] row_mask:0xf bank_mask:0xf
v_mov_b32_dpp v39, v56 quad_perm:[0,0,0,0] row_mask:0xf bank_mask:0xf
v_add_f32_dpp v39, v57, v39 quad_perm:[1,1,1,1] row_mask:0xf bank_mask:0xf
v_add_f32_dpp v39, v58, v39 quad_perm:[2,2,2,2] row_mask:0xf bank_mask:0xf
v_add_f32_dpp v39, v59, v39 quad_perm:[3,3,3,3] row_mask:0xf bank_mask:0xf
v_cvt_pk_bf16_f32 v12, v38, v39
v_lshlrev_b32 v38, 16, v12
v_and_b32 v39, 0xffff0000, v12
v_mul_f32 v38, s62, v38
v_mul_f32 v39, s62, v39
v_cvt_pk_bf16_f32 v12, v38, v39
v_lshlrev_b32 v38, 16, v12
v_and_b32 v39, 0xffff0000, v12
v_mov_b32_dpp v40, v60 quad_perm:[0,0,0,0] row_mask:0xf bank_mask:0xf
v_add_f32_dpp v40, v61, v40 quad_perm:[1,1,1,1] row_mask:0xf bank_mask:0xf
v_add_f32_dpp v40, v62, v40 quad_perm:[2,2,2,2] row_mask:0xf bank_mask:0xf
v_add_f32_dpp v40, v63, v40 quad_perm:[3,3,3,3] row_mask:0xf bank_mask:0xf
v_mov_b32_dpp v41, v64 quad_perm:[0,0,0,0] row_mask:0xf bank_mask:0xf
v_add_f32_dpp v41, v65, v41 quad_perm:[1,1,1,1] row_mask:0xf bank_mask:0xf
v_add_f32_dpp v41, v66, v41 quad_perm:[2,2,2,2] row_mask:0xf bank_mask:0xf
v_add_f32_dpp v41, v67, v41 quad_perm:[3,3,3,3] row_mask:0xf bank_mask:0xf
v_cvt_pk_bf16_f32 v12, v40, v41
v_lshlrev_b32 v40, 16, v12
v_and_b32 v41, 0xffff0000, v12
v_mul_f32 v40, s62, v40
v_mul_f32 v41, s62, v41
v_cvt_pk_bf16_f32 v12, v40, v41
v_lshlrev_b32 v40, 16, v12
v_and_b32 v41, 0xffff0000, v12
v_mov_b32_dpp v42, v68 quad_perm:[0,0,0,0] row_mask:0xf bank_mask:0xf
v_add_f32_dpp v42, v69, v42 quad_perm:[1,1,1,1] row_mask:0xf bank_mask:0xf
v_add_f32_dpp v42, v70, v42 quad_perm:[2,2,2,2] row_mask:0xf bank_mask:0xf
v_add_f32_dpp v42, v71, v42 quad_perm:[3,3,3,3] row_mask:0xf bank_mask:0xf
v_mov_b32_dpp v43, v72 quad_perm:[0,0,0,0] row_mask:0xf bank_mask:0xf
v_add_f32_dpp v43, v73, v43 quad_perm:[1,1,1,1] row_mask:0xf bank_mask:0xf
v_add_f32_dpp v43, v74, v43 quad_perm:[2,2,2,2] row_mask:0xf bank_mask:0xf
v_add_f32_dpp v43, v75, v43 quad_perm:[3,3,3,3] row_mask:0xf bank_mask:0xf
v_cvt_pk_bf16_f32 v12, v42, v43
v_lshlrev_b32 v42, 16, v12
v_and_b32 v43, 0xffff0000, v12
v_mul_f32 v42, s62, v42
v_mul_f32 v43, s62, v43
v_cvt_pk_bf16_f32 v12, v42, v43
v_lshlrev_b32 v42, 16, v12
v_and_b32 v43, 0xffff0000, v12
v_max3_f32 v11, v36, v37, v38
v_max3_f32 v11, v11, v39, v40
v_max3_f32 v11, v11, v41, v42
v_max_f32 v11, v11, v43
v_cmp_gt_f32 vcc, v11, v8
s_nop 3
s_cbranch_vccz L_norescale_4
v_mov_b32 v12, v11
s_nop 1
v_permlane16_swap_b32 v12, v11
v_max_f32 v11, v11, v12
v_mov_b32 v12, v11
s_nop 1
v_permlane32_swap_b32 v12, v11
v_max_f32 v11, v11, v12
v_max_f32 v11, v11, v8
v_sub_f32 v12, v8, v11
v_mul_f32 v12, s61, v12
v_exp_f32 v12, v12
v_mov_b32 v8, v11
v_mul_f32 v10, s61, v11
v_sub_f32 v10, 0, v10
v_mul_f32 v9, v9, v12
v_mov_b32_dpp v13, v12 row_ror:8 row_mask:0xf bank_mask:0xf
v_cndmask_b32 v13, v13, v12, s[64:65]
v_mul_f32 v24, v24, v13
v_mul_f32 v25, v25, v13
v_mul_f32 v26, v26, v13
v_mul_f32 v27, v27, v13
s_nop 1
L_norescale_4:
v_fma_f32 v36, v36, s61, v10
v_fma_f32 v37, v37, s61, v10
v_fma_f32 v38, v38, s61, v10
v_fma_f32 v39, v39, s61, v10
v_fma_f32 v40, v40, s61, v10
v_fma_f32 v41, v41, s61, v10
v_fma_f32 v42, v42, s61, v10
v_fma_f32 v43, v43, s61, v10
v_exp_f32 v36, v36
v_exp_f32 v37, v37
v_exp_f32 v38, v38
v_exp_f32 v39, v39
v_exp_f32 v40, v40
v_exp_f32 v41, v41
v_exp_f32 v42, v42
v_exp_f32 v43, v43
v_add_f32 v9, v9, v36
v_cvt_pk_bf16_f32 v36, v36, v36
v_add_f32 v9, v9, v37
v_cvt_pk_bf16_f32 v37, v37, v37
v_add_f32 v9, v9, v38
v_cvt_pk_bf16_f32 v38, v38, v38
v_add_f32 v9, v9, v39
v_cvt_pk_bf16_f32 v39, v39, v39
v_add_f32 v9, v9, v40
v_cvt_pk_bf16_f32 v40, v40, v40
v_add_f32 v9, v9, v41
v_cvt_pk_bf16_f32 v41, v41, v41
v_add_f32 v9, v9, v42
v_cvt_pk_bf16_f32 v42, v42, v42
v_add_f32 v9, v9, v43
v_cvt_pk_bf16_f32 v43, v43, v43
v_and_b32 v28, v20, v36
v_and_b32 v29, v21, v36
v_and_b32 v30, v22, v36
v_and_b32 v31, v23, v36
v_and_b32 v32, v20, v37
v_and_b32 v33, v21, v37
v_and_b32 v34, v22, v37
v_and_b32 v35, v23, v37
s_waitcnt vmcnt(15)
v_mfma_f32_16x16x32_bf16 v[24:27], v[28:31], v[108:111], v[24:27]
buffer_load_dwordx4 v[108:111], v4, s[48:51], s57 offen nt
v_and_b32 v28, v20, v38
v_and_b32 v29, v21, v38
v_and_b32 v30, v22, v38
v_and_b32 v31, v23, v38
s_waitcnt vmcnt(15)
v_mfma_f32_16x16x32_bf16 v[24:27], v[32:35], v[112:115], v[24:27]
buffer_load_dwordx4 v[112:115], v4, s[48:51], s69 offen nt
v_and_b32 v32, v20, v39
v_and_b32 v33, v21, v39
v_and_b32 v34, v22, v39
v_and_b32 v35, v23, v39
s_waitcnt vmcnt(15)
v_mfma_f32_16x16x32_bf16 v[24:27], v[28:31], v[116:119], v[24:27]
buffer_load_dwordx4 v[116:119], v4, s[48:51], s70 offen nt
v_and_b32 v28, v20, v40
v_and_b32 v29, v21, v40
v_and_b32 v30, v22, v40
v_and_b32 v31, v23, v40
s_waitcnt vmcnt(15)
v_mfma_f32_16x16x32_bf16 v[24:27], v[32:35], v[120:123], v[24:27]
buffer_load_dwordx4 v[120:123], v4, s[48:51], s71 offen nt
v_and_b32 v32, v20, v41
v_and_b32 v33, v21, v41
v_and_b32 v34, v22, v41
v_and_b32 v35, v23, v41
s_waitcnt vmcnt(15)
v_mfma_f32_16x16x32_bf16 v[24:27], v[28:31], v[124:127], v[24:27]
buffer_load_dwordx4 v[124:127], v4, s[48:51], s72 offen nt
v_and_b32 v28, v20, v42
v_and_b32 v29, v21, v42
v_and_b32 v30, v22, v42
v_and_b32 v31, v23, v42
s_waitcnt vmcnt(15)
v_mfma_f32_16x16x32_bf16 v[24:27], v[32:35], v[128:131], v[24:27]
buffer_load_dwordx4 v[128:131], v4, s[48:51], s73 offen nt
v_and_b32 v32, v20, v43
v_and_b32 v33, v21, v43
v_and_b32 v34, v22, v43
v_and_b32 v35, v23, v43
s_waitcnt vmcnt(15)
v_mfma_f32_16x16x32_bf16 v[24:27], v[28:31], v[132:135], v[24:27]
buffer_load_dwordx4 v[132:135], v4, s[48:51], s74 offen nt
s_waitcnt vmcnt(15)
v_mfma_f32_16x16x32_bf16 v[24:27], v[32:35], v[136:139], v[24:27]
buffer_load_dwordx4 v[136:139], v4, s[48:51], s75 offen nt
s_mov_b32 s54, s55
s_add_u32 s55, s55, 32
s_cmp_lt_u32 s56, 25
s_nop 2
s_cbranch_scc1 L_static
s_waitcnt lgkmcnt(0)
v_readfirstlane_b32 s53, v7
s_nop 0
s_and_b32 s58, s53, 15
s_lshl_b32 s58, s58, 2
v_mov_b32 v14, s58
s_mov_b32 s59, 8000000
s_nop 0
L_idwait:
ds_read_b32 v12, v6 offset:9044
ds_read_b32 v13, v14 offset:9056
s_waitcnt lgkmcnt(0)
v_readfirstlane_b32 s58, v12
v_readfirstlane_b32 s55, v13
s_cmp_gt_u32 s58, s53
s_nop 2
s_cbranch_scc1 L_static
s_mov_b32 s55, 1024
s_sleep 1
s_sub_u32 s59, s59, 1
s_cmp_lg_u32 s59, 0
s_cbranch_scc1 L_idwait
L_static:
s_add_u32 s56, s56, 1
s_cmp_lt_u32 s54, 1024
s_cbranch_scc1 L_loop
v_mov_b32 v12, v9
s_nop 1
v_permlane16_swap_b32 v12, v9
v_add_f32 v9, v9, v12
v_mov_b32 v12, v9
s_nop 1
v_permlane32_swap_b32 v12, v9
v_add_f32 v9, v9, v12
s_lshl_b32 s58, s3, 10
v_lshlrev_b32 v12, 4, v0
v_add_u32 v12, s58, v12
ds_write_b128 v12, v[24:27] offset:4864
s_lshl_b32 s58, s3, 4
v_add_u32 v12, s58, v0
s_mov_b64 exec, 0x101
ds_write_b64 v12, v[8:9] offset:8960
s_mov_b64 exec, 1
s_waitcnt lgkmcnt(0)
ds_add_u32 v6, v15 offset:9024
s_endpgm
L_auxq:
s_setprio 3
s_mov_b32 s48, s16
s_and_b32 s49, s17, 0xffff
s_mov_b32 s50, 2304
s_mov_b32 s51, 0x20000
s_mov_b32 s44, s22
s_and_b32 s45, s23, 0xffff
s_mov_b32 s46, 4718592
s_mov_b32 s47, 0x20000
v_mul_u32_u24 v15, 36, v0
buffer_load_dwordx3 v[24:26], v15, s[48:51], 0 offen offset:0
buffer_load_dwordx3 v[28:30], v15, s[48:51], 0 offen offset:12
buffer_load_dwordx3 v[32:34], v15, s[48:51], 0 offen offset:24
v_lshrrev_b32 v1, 3, v0
v_and_b32 v2, 7, v0
v_lshlrev_b32 v2, 4, v2
v_mov_b32 v8, 0
v_lshl_add_u32 v3, v1, 13, v2
s_and_b32 s58, s2, 3
s_lshr_b32 s59, s2, 2
s_mul_i32 s69, s58, 1179648
s_lshl_b32 s59, s59, 7
s_add_u32 s69, s69, s59
buffer_load_dwordx4 v[128:131], v3, s[44:47], s69 offen nt
s_add_u32 s69, s69, 65536
buffer_load_dwordx4 v[132:135], v3, s[44:47], s69 offen nt
s_add_u32 s69, s69, 65536
buffer_load_dwordx4 v[136:139], v3, s[44:47], s69 offen nt
s_add_u32 s69, s69, 65536
buffer_load_dwordx4 v[140:143], v3, s[44:47], s69 offen nt
s_add_u32 s69, s69, 65536
buffer_load_dwordx4 v[144:147], v3, s[44:47], s69 offen nt
s_add_u32 s69, s69, 65536
buffer_load_dwordx4 v[148:151], v3, s[44:47], s69 offen nt
s_add_u32 s69, s69, 65536
buffer_load_dwordx4 v[152:155], v3, s[44:47], s69 offen nt
s_add_u32 s69, s69, 65536
buffer_load_dwordx4 v[156:159], v3, s[44:47], s69 offen nt
s_add_u32 s69, s69, 65536
buffer_load_dwordx4 v[160:163], v3, s[44:47], s69 offen nt
s_add_u32 s69, s69, 65536
buffer_load_dwordx4 v[164:167], v3, s[44:47], s69 offen nt
s_add_u32 s69, s69, 65536
buffer_load_dwordx4 v[168:171], v3, s[44:47], s69 offen nt
s_add_u32 s69, s69, 65536
buffer_load_dwordx4 v[172:175], v3, s[44:47], s69 offen nt
s_add_u32 s69, s69, 65536
buffer_load_dwordx4 v[176:179], v3, s[44:47], s69 offen nt
s_add_u32 s69, s69, 65536
buffer_load_dwordx4 v[180:183], v3, s[44:47], s69 offen nt
s_add_u32 s69, s69, 65536
buffer_load_dwordx4 v[184:187], v3, s[44:47], s69 offen nt
s_add_u32 s69, s69, 65536
buffer_load_dwordx4 v[188:191], v3, s[44:47], s69 offen nt
s_add_u32 s69, s69, 65536
buffer_load_dwordx4 v[192:195], v3, s[44:47], s69 offen nt
s_add_u32 s69, s69, 65536
buffer_load_dwordx4 v[196:199], v3, s[44:47], s69 offen nt
v_mov_b32 v120, 0
v_mov_b32 v121, 0
v_mov_b32 v122, 0
v_mov_b32 v123, 0
ds_write_b128 v8, v[120:123] offset:9024
ds_write_b128 v8, v[120:123] offset:9040
s_waitcnt lgkmcnt(0)
s_barrier
s_load_dwordx2 s[82:83], s[38:39], 983040
v_lshlrev_b32 v6, 4, v0
s_mov_b32 s56, 0x00ff00ff
s_mov_b32 s57, 0x00ff00ff
s_mov_b32 s70, 0x3fb8aa3b
v_lshrrev_b32 v9, 5, v0
v_lshlrev_b32 v5, 8, v9
v_lshl_add_u32 v5, v2, 1, v5
v_bfe_u32 v9, v0, 4, 1
v_lshl_add_u32 v5, v9, 4, v5
v_bfe_u32 v7, v0, 3, 1
v_lshrrev_b32 v9, 4, v0
v_lshlrev_b32 v4, 2, v9
v_and_b32 v9, 1, v0
v_cmp_eq_u32 vcc, 1, v9
v_mov_b32 v10, 0x01000c0c
v_mov_b32 v11, 0x0c0c0100
v_cndmask_b32 v10, v11, v10, vcc
v_mov_b32 v12, 0x03020c0c
v_mov_b32 v11, 0x0c0c0302
v_cndmask_b32 v12, v11, v12, vcc
v_mov_b32 v11, 0x0c0c0c0c
v_bfe_u32 v9, v0, 1, 2
v_cmp_eq_u32 vcc, 0, v9
s_nop 1
v_cndmask_b32 v16, v11, v10, vcc
v_cndmask_b32 v20, v11, v12, vcc
v_cmp_eq_u32 vcc, 1, v9
s_nop 1
v_cndmask_b32 v17, v11, v10, vcc
v_cndmask_b32 v21, v11, v12, vcc
v_cmp_eq_u32 vcc, 2, v9
s_nop 1
v_cndmask_b32 v18, v11, v10, vcc
v_cndmask_b32 v22, v11, v12, vcc
v_cmp_eq_u32 vcc, 3, v9
s_nop 1
v_cndmask_b32 v19, v11, v10, vcc
v_cndmask_b32 v23, v11, v12, vcc
s_waitcnt vmcnt(18)
v_lshlrev_b32 v36, 16, v24
v_and_b32 v37, 0xffff0000, v24
v_lshlrev_b32 v38, 16, v25
v_and_b32 v39, 0xffff0000, v25
v_lshlrev_b32 v40, 16, v26
v_and_b32 v41, 0xffff0000, v26
v_lshlrev_b32 v42, 16, v28
v_and_b32 v43, 0xffff0000, v28
v_lshlrev_b32 v44, 16, v29
v_and_b32 v45, 0xffff0000, v29
v_lshlrev_b32 v46, 16, v30
v_and_b32 v47, 0xffff0000, v30
v_lshlrev_b32 v48, 16, v32
v_and_b32 v49, 0xffff0000, v32
v_lshlrev_b32 v50, 16, v33
v_and_b32 v51, 0xffff0000, v33
v_lshlrev_b32 v52, 16, v34
v_and_b32 v53, 0xffff0000, v34
v_add_f32 v54, v36, v37
v_add_f32 v55, v38, v39
v_add_f32 v54, v54, v40
v_add_f32 v55, v55, v41
v_add_f32 v54, v54, v42
v_add_f32 v55, v55, v43
v_add_f32 v54, v54, v44
v_add_f32 v55, v55, v45
v_add_f32 v54, v54, v46
v_add_f32 v55, v55, v47
v_add_f32 v54, v54, v48
v_add_f32 v55, v55, v49
v_add_f32 v54, v54, v50
v_add_f32 v55, v55, v51
v_add_f32 v54, v54, v52
v_add_f32 v55, v55, v53
v_add_f32 v54, v54, v55
s_nop 1
v_add_f32_dpp v54, v54, v54 quad_perm:[1,0,3,2] row_mask:0xf bank_mask:0xf
s_nop 1
v_add_f32_dpp v54, v54, v54 quad_perm:[2,3,0,1] row_mask:0xf bank_mask:0xf
s_nop 1
v_add_f32_dpp v54, v54, v54 row_half_mirror row_mask:0xf bank_mask:0xf
s_nop 1
v_add_f32_dpp v54, v54, v54 row_mirror row_mask:0xf bank_mask:0xf
v_mov_b32 v56, v54
s_nop 1
v_permlane16_swap_b32 v56, v54
v_add_f32 v54, v54, v56
v_mul_f32 v57, 0x3ae38e39, v54
v_sub_f32 v61, v36, v57
v_sub_f32 v62, v37, v57
v_mul_f32 v54, v61, v61
v_mul_f32 v55, v62, v62
v_sub_f32 v61, v38, v57
v_sub_f32 v62, v39, v57
v_fmac_f32 v54, v61, v61
v_fmac_f32 v55, v62, v62
v_sub_f32 v61, v40, v57
v_sub_f32 v62, v41, v57
v_fmac_f32 v54, v61, v61
v_fmac_f32 v55, v62, v62
v_sub_f32 v61, v42, v57
v_sub_f32 v62, v43, v57
v_fmac_f32 v54, v61, v61
v_fmac_f32 v55, v62, v62
v_sub_f32 v61, v44, v57
v_sub_f32 v62, v45, v57
v_fmac_f32 v54, v61, v61
v_fmac_f32 v55, v62, v62
v_sub_f32 v61, v46, v57
v_sub_f32 v62, v47, v57
v_fmac_f32 v54, v61, v61
v_fmac_f32 v55, v62, v62
v_sub_f32 v61, v48, v57
v_sub_f32 v62, v49, v57
v_fmac_f32 v54, v61, v61
v_fmac_f32 v55, v62, v62
v_sub_f32 v61, v50, v57
v_sub_f32 v62, v51, v57
v_fmac_f32 v54, v61, v61
v_fmac_f32 v55, v62, v62
v_sub_f32 v61, v52, v57
v_sub_f32 v62, v53, v57
v_fmac_f32 v54, v61, v61
v_fmac_f32 v55, v62, v62
v_add_f32 v54, v54, v55
s_nop 1
v_add_f32_dpp v54, v54, v54 quad_perm:[1,0,3,2] row_mask:0xf bank_mask:0xf
s_nop 1
v_add_f32_dpp v54, v54, v54 quad_perm:[2,3,0,1] row_mask:0xf bank_mask:0xf
s_nop 1
v_add_f32_dpp v54, v54, v54 row_half_mirror row_mask:0xf bank_mask:0xf
s_nop 1
v_add_f32_dpp v54, v54, v54 row_mirror row_mask:0xf bank_mask:0xf
v_mov_b32 v56, v54
s_nop 1
v_permlane16_swap_b32 v56, v54
v_add_f32 v54, v54, v56
v_mul_f32 v59, 0x3ae38e39, v54
v_cvt_pk_bf16_f32 v59, v59, v59
v_lshlrev_b32 v59, 16, v59
v_add_f32 v59, 0x3727c5ac, v59
v_cvt_pk_bf16_f32 v59, v59, v59
v_lshlrev_b32 v59, 16, v59
v_sqrt_f32 v59, v59
v_cvt_pk_bf16_f32 v58, v57, v57
v_lshlrev_b32 v58, 16, v58
v_cvt_pk_bf16_f32 v59, v59, v59
v_lshlrev_b32 v59, 16, v59
v_rcp_f32 v60, v59
v_sub_f32 v36, v36, v58
v_sub_f32 v37, v37, v58
v_cvt_pk_bf16_f32 v61, v36, v37
v_lshlrev_b32 v36, 16, v61
v_and_b32 v37, 0xffff0000, v61
v_mul_f32 v54, v36, v60
v_mul_f32 v55, v37, v60
v_fma_f32 v56, -v54, v59, v36
v_fma_f32 v62, -v55, v59, v37
v_fma_f32 v36, v56, v60, v54
v_fma_f32 v37, v62, v60, v55
v_cvt_pk_bf16_f32 v24, v36, v37
ds_write_b32 v15, v24 offset:0
v_sub_f32 v38, v38, v58
v_sub_f32 v39, v39, v58
v_cvt_pk_bf16_f32 v61, v38, v39
v_lshlrev_b32 v38, 16, v61
v_and_b32 v39, 0xffff0000, v61
v_mul_f32 v54, v38, v60
v_mul_f32 v55, v39, v60
v_fma_f32 v56, -v54, v59, v38
v_fma_f32 v62, -v55, v59, v39
v_fma_f32 v38, v56, v60, v54
v_fma_f32 v39, v62, v60, v55
v_cvt_pk_bf16_f32 v25, v38, v39
ds_write_b32 v15, v25 offset:4
v_sub_f32 v40, v40, v58
v_sub_f32 v41, v41, v58
v_cvt_pk_bf16_f32 v61, v40, v41
v_lshlrev_b32 v40, 16, v61
v_and_b32 v41, 0xffff0000, v61
v_mul_f32 v54, v40, v60
v_mul_f32 v55, v41, v60
v_fma_f32 v56, -v54, v59, v40
v_fma_f32 v62, -v55, v59, v41
v_fma_f32 v40, v56, v60, v54
v_fma_f32 v41, v62, v60, v55
v_cvt_pk_bf16_f32 v26, v40, v41
ds_write_b32 v15, v26 offset:8
v_sub_f32 v42, v42, v58
v_sub_f32 v43, v43, v58
v_cvt_pk_bf16_f32 v61, v42, v43
v_lshlrev_b32 v42, 16, v61
v_and_b32 v43, 0xffff0000, v61
v_mul_f32 v54, v42, v60
v_mul_f32 v55, v43, v60
v_fma_f32 v56, -v54, v59, v42
v_fma_f32 v62, -v55, v59, v43
v_fma_f32 v42, v56, v60, v54
v_fma_f32 v43, v62, v60, v55
v_cvt_pk_bf16_f32 v27, v42, v43
ds_write_b32 v15, v27 offset:12
v_sub_f32 v44, v44, v58
v_sub_f32 v45, v45, v58
v_cvt_pk_bf16_f32 v61, v44, v45
v_lshlrev_b32 v44, 16, v61
v_and_b32 v45, 0xffff0000, v61
v_mul_f32 v54, v44, v60
v_mul_f32 v55, v45, v60
v_fma_f32 v56, -v54, v59, v44
v_fma_f32 v62, -v55, v59, v45
v_fma_f32 v44, v56, v60, v54
v_fma_f32 v45, v62, v60, v55
v_cvt_pk_bf16_f32 v28, v44, v45
ds_write_b32 v15, v28 offset:16
v_sub_f32 v46, v46, v58
v_sub_f32 v47, v47, v58
v_cvt_pk_bf16_f32 v61, v46, v47
v_lshlrev_b32 v46, 16, v61
v_and_b32 v47, 0xffff0000, v61
v_mul_f32 v54, v46, v60
v_mul_f32 v55, v47, v60
v_fma_f32 v56, -v54, v59, v46
v_fma_f32 v62, -v55, v59, v47
v_fma_f32 v46, v56, v60, v54
v_fma_f32 v47, v62, v60, v55
v_cvt_pk_bf16_f32 v29, v46, v47
ds_write_b32 v15, v29 offset:20
v_sub_f32 v48, v48, v58
v_sub_f32 v49, v49, v58
v_cvt_pk_bf16_f32 v61, v48, v49
v_lshlrev_b32 v48, 16, v61
v_and_b32 v49, 0xffff0000, v61
v_mul_f32 v54, v48, v60
v_mul_f32 v55, v49, v60
v_fma_f32 v56, -v54, v59, v48
v_fma_f32 v62, -v55, v59, v49
v_fma_f32 v48, v56, v60, v54
v_fma_f32 v49, v62, v60, v55
v_cvt_pk_bf16_f32 v30, v48, v49
ds_write_b32 v15, v30 offset:24
v_sub_f32 v50, v50, v58
v_sub_f32 v51, v51, v58
v_cvt_pk_bf16_f32 v61, v50, v51
v_lshlrev_b32 v50, 16, v61
v_and_b32 v51, 0xffff0000, v61
v_mul_f32 v54, v50, v60
v_mul_f32 v55, v51, v60
v_fma_f32 v56, -v54, v59, v50
v_fma_f32 v62, -v55, v59, v51
v_fma_f32 v50, v56, v60, v54
v_fma_f32 v51, v62, v60, v55
v_cvt_pk_bf16_f32 v31, v50, v51
ds_write_b32 v15, v31 offset:28
v_sub_f32 v52, v52, v58
v_sub_f32 v53, v53, v58
v_cvt_pk_bf16_f32 v61, v52, v53
v_lshlrev_b32 v52, 16, v61
v_and_b32 v53, 0xffff0000, v61
v_mul_f32 v54, v52, v60
v_mul_f32 v55, v53, v60
v_fma_f32 v56, -v54, v59, v52
v_fma_f32 v62, -v55, v59, v53
v_fma_f32 v52, v56, v60, v54
v_fma_f32 v53, v62, v60, v55
v_cvt_pk_bf16_f32 v32, v52, v53
ds_write_b32 v15, v32 offset:32
v_mov_b32 v9, 1
s_waitcnt lgkmcnt(0)
ds_write_b32 v8, v9 offset:9032
s_and_b32 s58, s2, 3
s_mul_i32 s58, s58, 288
v_mul_u32_u24 v15, 1152, v7
v_add3_u32 v15, v15, v4, s58
s_lshl_b32 s65, s2, 10
s_add_u32 s65, s65, 720896
s_add_u32 s82, s82, 1
s_add_u32 s83, s83, 0x9e3779b9
s_waitcnt vmcnt(0)
ds_read_b32 v48, v15 offset:0
ds_read_b32 v49, v15 offset:16
ds_read_b32 v50, v15 offset:32
ds_read_b32 v51, v15 offset:48
ds_read_b32 v52, v15 offset:64
ds_read_b32 v53, v15 offset:80
ds_read_b32 v54, v15 offset:96
ds_read_b32 v55, v15 offset:112
ds_read_b32 v56, v15 offset:128
ds_read_b32 v57, v15 offset:144
ds_read_b32 v58, v15 offset:160
ds_read_b32 v59, v15 offset:176
ds_read_b32 v60, v15 offset:192
ds_read_b32 v61, v15 offset:208
ds_read_b32 v62, v15 offset:224
ds_read_b32 v63, v15 offset:240
ds_read_b32 v64, v15 offset:256
ds_read_b32 v65, v15 offset:272
s_waitcnt lgkmcnt(15)
v_perm_b32 v24, v48, v48, v16
v_perm_b32 v25, v48, v48, v17
v_perm_b32 v26, v48, v48, v18
v_perm_b32 v27, v48, v48, v19
v_perm_b32 v28, v48, v48, v20
v_perm_b32 v29, v48, v48, v21
v_perm_b32 v30, v48, v48, v22
v_perm_b32 v31, v48, v48, v23
s_waitcnt lgkmcnt(15)
v_perm_b32 v32, v49, v49, v16
v_perm_b32 v33, v49, v49, v17
v_perm_b32 v34, v49, v49, v18
v_perm_b32 v35, v49, v49, v19
v_perm_b32 v36, v49, v49, v20
v_perm_b32 v37, v49, v49, v21
v_perm_b32 v38, v49, v49, v22
v_perm_b32 v39, v49, v49, v23
v_mfma_f32_16x16x32_bf16 v[40:43], v[24:27], v[128:131], 0
v_mfma_f32_16x16x32_bf16 v[44:47], v[28:31], v[128:131], 0
s_waitcnt lgkmcnt(15)
v_perm_b32 v24, v50, v50, v16
v_perm_b32 v25, v50, v50, v17
v_perm_b32 v26, v50, v50, v18
v_perm_b32 v27, v50, v50, v19
v_perm_b32 v28, v50, v50, v20
v_perm_b32 v29, v50, v50, v21
v_perm_b32 v30, v50, v50, v22
v_perm_b32 v31, v50, v50, v23
v_mfma_f32_16x16x32_bf16 v[40:43], v[32:35], v[132:135], v[40:43]
v_mfma_f32_16x16x32_bf16 v[44:47], v[36:39], v[132:135], v[44:47]
s_waitcnt lgkmcnt(14)
v_perm_b32 v32, v51, v51, v16
v_perm_b32 v33, v51, v51, v17
v_perm_b32 v34, v51, v51, v18
v_perm_b32 v35, v51, v51, v19
v_perm_b32 v36, v51, v51, v20
v_perm_b32 v37, v51, v51, v21
v_perm_b32 v38, v51, v51, v22
v_perm_b32 v39, v51, v51, v23
v_mfma_f32_16x16x32_bf16 v[40:43], v[24:27], v[136:139], v[40:43]
v_mfma_f32_16x16x32_bf16 v[44:47], v[28:31], v[136:139], v[44:47]
s_waitcnt lgkmcnt(13)
v_perm_b32 v24, v52, v52, v16
v_perm_b32 v25, v52, v52, v17
v_perm_b32 v26, v52, v52, v18
v_perm_b32 v27, v52, v52, v19
v_perm_b32 v28, v52, v52, v20
v_perm_b32 v29, v52, v52, v21
v_perm_b32 v30, v52, v52, v22
v_perm_b32 v31, v52, v52, v23
v_mfma_f32_16x16x32_bf16 v[40:43], v[32:35], v[140:143], v[40:43]
v_mfma_f32_16x16x32_bf16 v[44:47], v[36:39], v[140:143], v[44:47]
s_waitcnt lgkmcnt(12)
v_perm_b32 v32, v53, v53, v16
v_perm_b32 v33, v53, v53, v17
v_perm_b32 v34, v53, v53, v18
v_perm_b32 v35, v53, v53, v19
v_perm_b32 v36, v53, v53, v20
v_perm_b32 v37, v53, v53, v21
v_perm_b32 v38, v53, v53, v22
v_perm_b32 v39, v53, v53, v23
v_mfma_f32_16x16x32_bf16 v[40:43], v[24:27], v[144:147], v[40:43]
v_mfma_f32_16x16x32_bf16 v[44:47], v[28:31], v[144:147], v[44:47]
s_waitcnt lgkmcnt(11)
v_perm_b32 v24, v54, v54, v16
v_perm_b32 v25, v54, v54, v17
v_perm_b32 v26, v54, v54, v18
v_perm_b32 v27, v54, v54, v19
v_perm_b32 v28, v54, v54, v20
v_perm_b32 v29, v54, v54, v21
v_perm_b32 v30, v54, v54, v22
v_perm_b32 v31, v54, v54, v23
v_mfma_f32_16x16x32_bf16 v[40:43], v[32:35], v[148:151], v[40:43]
v_mfma_f32_16x16x32_bf16 v[44:47], v[36:39], v[148:151], v[44:47]
s_waitcnt lgkmcnt(10)
v_perm_b32 v32, v55, v55, v16
v_perm_b32 v33, v55, v55, v17
v_perm_b32 v34, v55, v55, v18
v_perm_b32 v35, v55, v55, v19
v_perm_b32 v36, v55, v55, v20
v_perm_b32 v37, v55, v55, v21
v_perm_b32 v38, v55, v55, v22
v_perm_b32 v39, v55, v55, v23
v_mfma_f32_16x16x32_bf16 v[40:43], v[24:27], v[152:155], v[40:43]
v_mfma_f32_16x16x32_bf16 v[44:47], v[28:31], v[152:155], v[44:47]
s_waitcnt lgkmcnt(9)
v_perm_b32 v24, v56, v56, v16
v_perm_b32 v25, v56, v56, v17
v_perm_b32 v26, v56, v56, v18
v_perm_b32 v27, v56, v56, v19
v_perm_b32 v28, v56, v56, v20
v_perm_b32 v29, v56, v56, v21
v_perm_b32 v30, v56, v56, v22
v_perm_b32 v31, v56, v56, v23
v_mfma_f32_16x16x32_bf16 v[40:43], v[32:35], v[156:159], v[40:43]
v_mfma_f32_16x16x32_bf16 v[44:47], v[36:39], v[156:159], v[44:47]
s_waitcnt lgkmcnt(8)
v_perm_b32 v32, v57, v57, v16
v_perm_b32 v33, v57, v57, v17
v_perm_b32 v34, v57, v57, v18
v_perm_b32 v35, v57, v57, v19
v_perm_b32 v36, v57, v57, v20
v_perm_b32 v37, v57, v57, v21
v_perm_b32 v38, v57, v57, v22
v_perm_b32 v39, v57, v57, v23
v_mfma_f32_16x16x32_bf16 v[40:43], v[24:27], v[160:163], v[40:43]
v_mfma_f32_16x16x32_bf16 v[44:47], v[28:31], v[160:163], v[44:47]
s_waitcnt lgkmcnt(7)
v_perm_b32 v24, v58, v58, v16
v_perm_b32 v25, v58, v58, v17
v_perm_b32 v26, v58, v58, v18
v_perm_b32 v27, v58, v58, v19
v_perm_b32 v28, v58, v58, v20
v_perm_b32 v29, v58, v58, v21
v_perm_b32 v30, v58, v58, v22
v_perm_b32 v31, v58, v58, v23
v_mfma_f32_16x16x32_bf16 v[40:43], v[32:35], v[164:167], v[40:43]
v_mfma_f32_16x16x32_bf16 v[44:47], v[36:39], v[164:167], v[44:47]
s_waitcnt lgkmcnt(6)
v_perm_b32 v32, v59, v59, v16
v_perm_b32 v33, v59, v59, v17
v_perm_b32 v34, v59, v59, v18
v_perm_b32 v35, v59, v59, v19
v_perm_b32 v36, v59, v59, v20
v_perm_b32 v37, v59, v59, v21
v_perm_b32 v38, v59, v59, v22
v_perm_b32 v39, v59, v59, v23
v_mfma_f32_16x16x32_bf16 v[40:43], v[24:27], v[168:171], v[40:43]
v_mfma_f32_16x16x32_bf16 v[44:47], v[28:31], v[168:171], v[44:47]
s_waitcnt lgkmcnt(5)
v_perm_b32 v24, v60, v60, v16
v_perm_b32 v25, v60, v60, v17
v_perm_b32 v26, v60, v60, v18
v_perm_b32 v27, v60, v60, v19
v_perm_b32 v28, v60, v60, v20
v_perm_b32 v29, v60, v60, v21
v_perm_b32 v30, v60, v60, v22
v_perm_b32 v31, v60, v60, v23
v_mfma_f32_16x16x32_bf16 v[40:43], v[32:35], v[172:175], v[40:43]
v_mfma_f32_16x16x32_bf16 v[44:47], v[36:39], v[172:175], v[44:47]
s_waitcnt lgkmcnt(4)
v_perm_b32 v32, v61, v61, v16
v_perm_b32 v33, v61, v61, v17
v_perm_b32 v34, v61, v61, v18
v_perm_b32 v35, v61, v61, v19
v_perm_b32 v36, v61, v61, v20
v_perm_b32 v37, v61, v61, v21
v_perm_b32 v38, v61, v61, v22
v_perm_b32 v39, v61, v61, v23
v_mfma_f32_16x16x32_bf16 v[40:43], v[24:27], v[176:179], v[40:43]
v_mfma_f32_16x16x32_bf16 v[44:47], v[28:31], v[176:179], v[44:47]
s_waitcnt lgkmcnt(3)
v_perm_b32 v24, v62, v62, v16
v_perm_b32 v25, v62, v62, v17
v_perm_b32 v26, v62, v62, v18
v_perm_b32 v27, v62, v62, v19
v_perm_b32 v28, v62, v62, v20
v_perm_b32 v29, v62, v62, v21
v_perm_b32 v30, v62, v62, v22
v_perm_b32 v31, v62, v62, v23
v_mfma_f32_16x16x32_bf16 v[40:43], v[32:35], v[180:183], v[40:43]
v_mfma_f32_16x16x32_bf16 v[44:47], v[36:39], v[180:183], v[44:47]
s_waitcnt lgkmcnt(2)
v_perm_b32 v32, v63, v63, v16
v_perm_b32 v33, v63, v63, v17
v_perm_b32 v34, v63, v63, v18
v_perm_b32 v35, v63, v63, v19
v_perm_b32 v36, v63, v63, v20
v_perm_b32 v37, v63, v63, v21
v_perm_b32 v38, v63, v63, v22
v_perm_b32 v39, v63, v63, v23
v_mfma_f32_16x16x32_bf16 v[40:43], v[24:27], v[184:187], v[40:43]
v_mfma_f32_16x16x32_bf16 v[44:47], v[28:31], v[184:187], v[44:47]
s_waitcnt lgkmcnt(1)
v_perm_b32 v24, v64, v64, v16
v_perm_b32 v25, v64, v64, v17
v_perm_b32 v26, v64, v64, v18
v_perm_b32 v27, v64, v64, v19
v_perm_b32 v28, v64, v64, v20
v_perm_b32 v29, v64, v64, v21
v_perm_b32 v30, v64, v64, v22
v_perm_b32 v31, v64, v64, v23
v_mfma_f32_16x16x32_bf16 v[40:43], v[32:35], v[188:191], v[40:43]
v_mfma_f32_16x16x32_bf16 v[44:47], v[36:39], v[188:191], v[44:47]
s_waitcnt lgkmcnt(0)
v_perm_b32 v32, v65, v65, v16
v_perm_b32 v33, v65, v65, v17
v_perm_b32 v34, v65, v65, v18
v_perm_b32 v35, v65, v65, v19
v_perm_b32 v36, v65, v65, v20
v_perm_b32 v37, v65, v65, v21
v_perm_b32 v38, v65, v65, v22
v_perm_b32 v39, v65, v65, v23
v_mfma_f32_16x16x32_bf16 v[40:43], v[24:27], v[192:195], v[40:43]
v_mfma_f32_16x16x32_bf16 v[44:47], v[28:31], v[192:195], v[44:47]
v_mfma_f32_16x16x32_bf16 v[40:43], v[32:35], v[196:199], v[40:43]
v_mfma_f32_16x16x32_bf16 v[44:47], v[36:39], v[196:199], v[44:47]
s_nop 7
v_add_f32_dpp v40, v44, v40 row_ror:8 row_mask:0xf bank_mask:0xf
v_add_f32_dpp v41, v45, v41 row_ror:8 row_mask:0xf bank_mask:0xf
v_add_f32_dpp v42, v46, v42 row_ror:8 row_mask:0xf bank_mask:0xf
v_add_f32_dpp v43, v47, v43 row_ror:8 row_mask:0xf bank_mask:0xf
v_mov_b32 v44, v42
v_mov_b32 v45, v43
v_mov_b32 v42, s82
v_mov_b32 v43, s83
v_mov_b32 v46, s82
v_mov_b32 v47, s83
v_lshlrev_b32 v9, 1, v5
s_mov_b64 exec, s[56:57]
buffer_store_dwordx4 v[40:43], v9, s[40:43], s65 offen sc1
buffer_store_dwordx4 v[44:47], v9, s[40:43], s65 offen offset:16 sc1
s_mov_b64 exec, -1
s_lshr_b32 s58, s2, 3
s_lshr_b32 s59, s58, 4
s_and_b32 s58, s58, 15
s_lshl_b32 s58, s58, 14
s_lshl_b32 s59, s59, 9
s_add_u32 s58, s58, s59
s_add_u32 s58, s58, 720896
v_lshrrev_b32 v9, 4, v0
v_lshlrev_b32 v9, 12, v9
v_and_b32 v10, 15, v0
v_lshl_add_u32 v14, v10, 5, v9
v_lshlrev_b32 v13, 3, v0
s_mov_b32 s62, 1000000
s_nop 0
L_qp_5:
buffer_load_dwordx4 v[48:51], v14, s[40:43], s58 offen offset:0 sc1
buffer_load_dwordx4 v[52:55], v14, s[40:43], s58 offen offset:16 sc1
buffer_load_dwordx4 v[56:59], v14, s[40:43], s58 offen offset:1024 sc1
buffer_load_dwordx4 v[60:63], v14, s[40:43], s58 offen offset:1040 sc1
buffer_load_dwordx4 v[64:67], v14, s[40:43], s58 offen offset:2048 sc1
buffer_load_dwordx4 v[68:71], v14, s[40:43], s58 offen offset:2064 sc1
buffer_load_dwordx4 v[72:75], v14, s[40:43], s58 offen offset:3072 sc1
buffer_load_dwordx4 v[76:79], v14, s[40:43], s58 offen offset:3088 sc1
v_mov_b32 v9, 0
s_waitcnt vmcnt(7)
v_xor_b32 v10, s82, v50
v_xor_b32 v11, s83, v51
v_or3_b32 v9, v9, v10, v11
s_waitcnt vmcnt(6)
v_xor_b32 v10, s82, v54
v_xor_b32 v11, s83, v55
v_or3_b32 v9, v9, v10, v11
s_waitcnt vmcnt(5)
v_xor_b32 v10, s82, v58
v_xor_b32 v11, s83, v59
v_or3_b32 v9, v9, v10, v11
s_waitcnt vmcnt(4)
v_xor_b32 v10, s82, v62
v_xor_b32 v11, s83, v63
v_or3_b32 v9, v9, v10, v11
s_waitcnt vmcnt(3)
v_xor_b32 v10, s82, v66
v_xor_b32 v11, s83, v67
v_or3_b32 v9, v9, v10, v11
s_waitcnt vmcnt(2)
v_xor_b32 v10, s82, v70
v_xor_b32 v11, s83, v71
v_or3_b32 v9, v9, v10, v11
s_waitcnt vmcnt(1)
v_xor_b32 v10, s82, v74
v_xor_b32 v11, s83, v75
v_or3_b32 v9, v9, v10, v11
s_waitcnt vmcnt(0)
v_xor_b32 v10, s82, v78
v_xor_b32 v11, s83, v79
v_or3_b32 v9, v9, v10, v11
v_cmp_ne_u32 vcc, 0, v9
s_nop 3
s_cbranch_vccz L_qpd_6
s_sleep 1
s_sub_u32 s62, s62, 1
s_cmp_lg_u32 s62, 0
s_cbranch_scc1 L_qp_5
L_qpd_6:
v_add_f32 v48, v48, v56
v_add_f32 v64, v64, v72
v_add_f32 v49, v49, v57
v_add_f32 v65, v65, v73
v_add_f32 v52, v52, v60
v_add_f32 v68, v68, v76
v_add_f32 v53, v53, v61
v_add_f32 v69, v69, v77
v_add_f32 v48, v48, v64
v_add_f32 v49, v49, v65
v_add_f32 v52, v52, v68
v_add_f32 v53, v53, v69
v_cvt_pk_bf16_f32 v120, v48, v49
v_cvt_pk_bf16_f32 v121, v52, v53
ds_write_b64 v13, v[120:121] offset:2304
v_mov_b32 v9, 1
s_waitcnt lgkmcnt(0)
ds_write_b32 v8, v9 offset:9036
s_lshr_b32 s78, s2, 3
s_and_b32 s79, s2, 7
s_lshl_b32 s58, s79, 5
s_add_u32 s58, s58, s78
s_cmp_lt_u32 s58, 144
s_cselect_b32 s73, 1, 0
s_mul_i32 s76, s58, 57
s_lshr_b32 s76, s76, 9
s_mul_i32 s77, s76, 9
s_sub_u32 s77, s58, s77
s_mul_i32 s59, s77, 50
s_lshl_b32 s60, s76, 1
s_add_u32 s59, s59, s60
s_lshl_b32 s59, s59, 9
s_add_u32 s68, s59, 414208
s_cmp_eq_u32 s79, 7
s_cselect_b32 s71, 1, 0
s_cmp_lt_u32 s2, 72
s_cselect_b32 s71, s71, 0
s_lshl_b32 s81, s78, 7
s_mul_i32 s80, s78, 25600
s_add_u32 s80, s80, 413696
s_cmp_eq_u32 s73, 0
s_cbranch_scc1 L_nowo_7
s_mov_b32 s44, s24
s_and_b32 s45, s25, 0xffff
s_mov_b32 s46, 4718592
s_mov_b32 s47, 0x20000
v_mul_u32_u24 v3, 1152, v1
v_add_u32 v3, v3, v2
s_mul_i32 s69, s76, 294912
s_lshl_b32 s58, s77, 7
s_add_u32 s69, s69, s58
s_add_u32 s69, s69, 147456
buffer_load_dwordx4 v[128:131], v3, s[44:47], s69 offen nt
s_add_u32 s69, s69, 9216
buffer_load_dwordx4 v[132:135], v3, s[44:47], s69 offen nt
s_add_u32 s69, s69, 9216
buffer_load_dwordx4 v[136:139], v3, s[44:47], s69 offen nt
s_add_u32 s69, s69, 9216
buffer_load_dwordx4 v[140:143], v3, s[44:47], s69 offen nt
s_add_u32 s69, s69, 9216
buffer_load_dwordx4 v[144:147], v3, s[44:47], s69 offen nt
s_add_u32 s69, s69, 9216
buffer_load_dwordx4 v[148:151], v3, s[44:47], s69 offen nt
s_add_u32 s69, s69, 9216
buffer_load_dwordx4 v[152:155], v3, s[44:47], s69 offen nt
s_add_u32 s69, s69, 9216
buffer_load_dwordx4 v[156:159], v3, s[44:47], s69 offen nt
s_add_u32 s69, s69, 9216
buffer_load_dwordx4 v[160:163], v3, s[44:47], s69 offen nt
s_add_u32 s69, s69, 9216
buffer_load_dwordx4 v[164:167], v3, s[44:47], s69 offen nt
s_add_u32 s69, s69, 9216
buffer_load_dwordx4 v[168:171], v3, s[44:47], s69 offen nt
s_add_u32 s69, s69, 9216
buffer_load_dwordx4 v[172:175], v3, s[44:47], s69 offen nt
s_add_u32 s69, s69, 9216
buffer_load_dwordx4 v[176:179], v3, s[44:47], s69 offen nt
s_add_u32 s69, s69, 9216
buffer_load_dwordx4 v[180:183], v3, s[44:47], s69 offen nt
s_add_u32 s69, s69, 9216
buffer_load_dwordx4 v[184:187], v3, s[44:47], s69 offen nt
s_add_u32 s69, s69, 9216
buffer_load_dwordx4 v[188:191], v3, s[44:47], s69 offen nt
v_lshrrev_b32 v9, 5, v0
v_and_b32 v10, 31, v0
v_lshlrev_b32 v14, 17, v9
v_lshl_add_u32 v14, v10, 4, v14
v_lshlrev_b32 v15, 11, v9
v_lshlrev_b32 v13, 9, v9
v_and_b32 v10, 15, v0
v_lshl_add_u32 v13, v10, 4, v13
v_bfe_u32 v10, v0, 4, 1
v_lshl_add_u32 v13, v10, 3, v13
s_waitcnt vmcnt(0)
ds_write_b128 v6, v[128:131] offset:25600
ds_write_b128 v6, v[132:135] offset:26624
ds_write_b128 v6, v[136:139] offset:27648
ds_write_b128 v6, v[140:143] offset:28672
ds_write_b128 v6, v[144:147] offset:29696
ds_write_b128 v6, v[148:151] offset:30720
ds_write_b128 v6, v[152:155] offset:31744
ds_write_b128 v6, v[156:159] offset:32768
ds_write_b128 v6, v[160:163] offset:33792
ds_write_b128 v6, v[164:167] offset:34816
ds_write_b128 v6, v[168:171] offset:35840
ds_write_b128 v6, v[172:175] offset:36864
ds_write_b128 v6, v[176:179] offset:37888
ds_write_b128 v6, v[180:183] offset:38912
ds_write_b128 v6, v[184:187] offset:39936
ds_write_b128 v6, v[188:191] offset:40960
v_and_b32 v10, 15, v0
v_lshlrev_b32 v10, 1, v10
v_lshl_add_u32 v12, v4, 8, v10
ds_read_u16 v24, v12 offset:25600
ds_read_u16 v25, v12 offset:25728
ds_read_u16 v26, v12 offset:25856
ds_read_u16 v27, v12 offset:25984
ds_read_u16 v28, v12 offset:26112
ds_read_u16 v29, v12 offset:26240
ds_read_u16 v30, v12 offset:26368
ds_read_u16 v31, v12 offset:26496
s_waitcnt lgkmcnt(0)
v_lshl_or_b32 v192, v25, 16, v24
v_lshl_or_b32 v193, v27, 16, v26
v_lshl_or_b32 v194, v29, 16, v28
v_lshl_or_b32 v195, v31, 16, v30
ds_read_u16 v24, v12 offset:25632
ds_read_u16 v25, v12 offset:25760
ds_read_u16 v26, v12 offset:25888
ds_read_u16 v27, v12 offset:26016
ds_read_u16 v28, v12 offset:26144
ds_read_u16 v29, v12 offset:26272
ds_read_u16 v30, v12 offset:26400
ds_read_u16 v31, v12 offset:26528
s_waitcnt lgkmcnt(0)
v_lshl_or_b32 v196, v25, 16, v24
v_lshl_or_b32 v197, v27, 16, v26
v_lshl_or_b32 v198, v29, 16, v28
v_lshl_or_b32 v199, v31, 16, v30
ds_read_u16 v24, v12 offset:25664
ds_read_u16 v25, v12 offset:25792
ds_read_u16 v26, v12 offset:25920
ds_read_u16 v27, v12 offset:26048
ds_read_u16 v28, v12 offset:26176
ds_read_u16 v29, v12 offset:26304
ds_read_u16 v30, v12 offset:26432
ds_read_u16 v31, v12 offset:26560
s_waitcnt lgkmcnt(0)
v_lshl_or_b32 v200, v25, 16, v24
v_lshl_or_b32 v201, v27, 16, v26
v_lshl_or_b32 v202, v29, 16, v28
v_lshl_or_b32 v203, v31, 16, v30
ds_read_u16 v24, v12 offset:25696
ds_read_u16 v25, v12 offset:25824
ds_read_u16 v26, v12 offset:25952
ds_read_u16 v27, v12 offset:26080
ds_read_u16 v28, v12 offset:26208
ds_read_u16 v29, v12 offset:26336
ds_read_u16 v30, v12 offset:26464
ds_read_u16 v31, v12 offset:26592
s_waitcnt lgkmcnt(0)
v_lshl_or_b32 v204, v25, 16, v24
v_lshl_or_b32 v205, v27, 16, v26
v_lshl_or_b32 v206, v29, 16, v28
v_lshl_or_b32 v207, v31, 16, v30
ds_read_u16 v24, v12 offset:29696
ds_read_u16 v25, v12 offset:29824
ds_read_u16 v26, v12 offset:29952
ds_read_u16 v27, v12 offset:30080
ds_read_u16 v28, v12 offset:30208
ds_read_u16 v29, v12 offset:30336
ds_read_u16 v30, v12 offset:30464
ds_read_u16 v31, v12 offset:30592
s_waitcnt lgkmcnt(0)
v_lshl_or_b32 v208, v25, 16, v24
v_lshl_or_b32 v209, v27, 16, v26
v_lshl_or_b32 v210, v29, 16, v28
v_lshl_or_b32 v211, v31, 16, v30
ds_read_u16 v24, v12 offset:29728
ds_read_u16 v25, v12 offset:29856
ds_read_u16 v26, v12 offset:29984
ds_read_u16 v27, v12 offset:30112
ds_read_u16 v28, v12 offset:30240
ds_read_u16 v29, v12 offset:30368
ds_read_u16 v30, v12 offset:30496
ds_read_u16 v31, v12 offset:30624
s_waitcnt lgkmcnt(0)
v_lshl_or_b32 v212, v25, 16, v24
v_lshl_or_b32 v213, v27, 16, v26
v_lshl_or_b32 v214, v29, 16, v28
v_lshl_or_b32 v215, v31, 16, v30
ds_read_u16 v24, v12 offset:29760
ds_read_u16 v25, v12 offset:29888
ds_read_u16 v26, v12 offset:30016
ds_read_u16 v27, v12 offset:30144
ds_read_u16 v28, v12 offset:30272
ds_read_u16 v29, v12 offset:30400
ds_read_u16 v30, v12 offset:30528
ds_read_u16 v31, v12 offset:30656
s_waitcnt lgkmcnt(0)
v_lshl_or_b32 v216, v25, 16, v24
v_lshl_or_b32 v217, v27, 16, v26
v_lshl_or_b32 v218, v29, 16, v28
v_lshl_or_b32 v219, v31, 16, v30
ds_read_u16 v24, v12 offset:29792
ds_read_u16 v25, v12 offset:29920
ds_read_u16 v26, v12 offset:30048
ds_read_u16 v27, v12 offset:30176
ds_read_u16 v28, v12 offset:30304
ds_read_u16 v29, v12 offset:30432
ds_read_u16 v30, v12 offset:30560
ds_read_u16 v31, v12 offset:30688
s_waitcnt lgkmcnt(0)
v_lshl_or_b32 v220, v25, 16, v24
v_lshl_or_b32 v221, v27, 16, v26
v_lshl_or_b32 v222, v29, 16, v28
v_lshl_or_b32 v223, v31, 16, v30
ds_read_u16 v24, v12 offset:33792
ds_read_u16 v25, v12 offset:33920
ds_read_u16 v26, v12 offset:34048
ds_read_u16 v27, v12 offset:34176
ds_read_u16 v28, v12 offset:34304
ds_read_u16 v29, v12 offset:34432
ds_read_u16 v30, v12 offset:34560
ds_read_u16 v31, v12 offset:34688
s_waitcnt lgkmcnt(0)
v_lshl_or_b32 v224, v25, 16, v24
v_lshl_or_b32 v225, v27, 16, v26
v_lshl_or_b32 v226, v29, 16, v28
v_lshl_or_b32 v227, v31, 16, v30
ds_read_u16 v24, v12 offset:33824
ds_read_u16 v25, v12 offset:33952
ds_read_u16 v26, v12 offset:34080
ds_read_u16 v27, v12 offset:34208
ds_read_u16 v28, v12 offset:34336
ds_read_u16 v29, v12 offset:34464
ds_read_u16 v30, v12 offset:34592
ds_read_u16 v31, v12 offset:34720
s_waitcnt lgkmcnt(0)
v_lshl_or_b32 v228, v25, 16, v24
v_lshl_or_b32 v229, v27, 16, v26
v_lshl_or_b32 v230, v29, 16, v28
v_lshl_or_b32 v231, v31, 16, v30
ds_read_u16 v24, v12 offset:33856
ds_read_u16 v25, v12 offset:33984
ds_read_u16 v26, v12 offset:34112
ds_read_u16 v27, v12 offset:34240
ds_read_u16 v28, v12 offset:34368
ds_read_u16 v29, v12 offset:34496
ds_read_u16 v30, v12 offset:34624
ds_read_u16 v31, v12 offset:34752
s_waitcnt lgkmcnt(0)
v_lshl_or_b32 v232, v25, 16, v24
v_lshl_or_b32 v233, v27, 16, v26
v_lshl_or_b32 v234, v29, 16, v28
v_lshl_or_b32 v235, v31, 16, v30
ds_read_u16 v24, v12 offset:33888
ds_read_u16 v25, v12 offset:34016
ds_read_u16 v26, v12 offset:34144
ds_read_u16 v27, v12 offset:34272
ds_read_u16 v28, v12 offset:34400
ds_read_u16 v29, v12 offset:34528
ds_read_u16 v30, v12 offset:34656
ds_read_u16 v31, v12 offset:34784
s_waitcnt lgkmcnt(0)
v_lshl_or_b32 v236, v25, 16, v24
v_lshl_or_b32 v237, v27, 16, v26
v_lshl_or_b32 v238, v29, 16, v28
v_lshl_or_b32 v239, v31, 16, v30
ds_read_u16 v24, v12 offset:37888
ds_read_u16 v25, v12 offset:38016
ds_read_u16 v26, v12 offset:38144
ds_read_u16 v27, v12 offset:38272
ds_read_u16 v28, v12 offset:38400
ds_read_u16 v29, v12 offset:38528
ds_read_u16 v30, v12 offset:38656
ds_read_u16 v31, v12 offset:38784
s_waitcnt lgkmcnt(0)
v_lshl_or_b32 v240, v25, 16, v24
v_lshl_or_b32 v241, v27, 16, v26
v_lshl_or_b32 v242, v29, 16, v28
v_lshl_or_b32 v243, v31, 16, v30
ds_read_u16 v24, v12 offset:37920
ds_read_u16 v25, v12 offset:38048
ds_read_u16 v26, v12 offset:38176
ds_read_u16 v27, v12 offset:38304
ds_read_u16 v28, v12 offset:38432
ds_read_u16 v29, v12 offset:38560
ds_read_u16 v30, v12 offset:38688
ds_read_u16 v31, v12 offset:38816
s_waitcnt lgkmcnt(0)
v_lshl_or_b32 v244, v25, 16, v24
v_lshl_or_b32 v245, v27, 16, v26
v_lshl_or_b32 v246, v29, 16, v28
v_lshl_or_b32 v247, v31, 16, v30
ds_read_u16 v24, v12 offset:37952
ds_read_u16 v25, v12 offset:38080
ds_read_u16 v26, v12 offset:38208
ds_read_u16 v27, v12 offset:38336
ds_read_u16 v28, v12 offset:38464
ds_read_u16 v29, v12 offset:38592
ds_read_u16 v30, v12 offset:38720
ds_read_u16 v31, v12 offset:38848
s_waitcnt lgkmcnt(0)
v_lshl_or_b32 v248, v25, 16, v24
v_lshl_or_b32 v249, v27, 16, v26
v_lshl_or_b32 v250, v29, 16, v28
v_lshl_or_b32 v251, v31, 16, v30
ds_read_u16 v24, v12 offset:37984
ds_read_u16 v25, v12 offset:38112
ds_read_u16 v26, v12 offset:38240
ds_read_u16 v27, v12 offset:38368
ds_read_u16 v28, v12 offset:38496
ds_read_u16 v29, v12 offset:38624
ds_read_u16 v30, v12 offset:38752
ds_read_u16 v31, v12 offset:38880
s_waitcnt lgkmcnt(0)
v_lshl_or_b32 v252, v25, 16, v24
v_lshl_or_b32 v253, v27, 16, v26
v_lshl_or_b32 v254, v29, 16, v28
v_lshl_or_b32 v255, v31, 16, v30
v_and_b32 v10, 1, v0
v_lshlrev_b32 v10, 9, v10
v_lshl_add_u32 v12, v4, 2, v10
v_lshlrev_b32 v5, 3, v0
s_lshl_b32 s87, s76, 13
s_add_u32 s87, s87, 147968
s_add_u32 s88, s87, 4096
s_lshl_b32 s89, s76, 7
s_add_u32 s89, s89, 409608
L_nowo_7:
s_mov_b32 s62, 8000000
L_ld_8:
ds_read_b32 v9, v8 offset:9028
s_waitcnt lgkmcnt(0)
v_cmp_ne_u32 vcc, 1, v9
s_nop 3
s_cbranch_vccz L_ldd_9
s_sleep 8
s_sub_u32 s62, s62, 1
s_cmp_lg_u32 s62, 0
s_cbranch_scc1 L_ld_8
L_ldd_9:
s_mov_b32 s84, 0
s_mov_b32 s86, 0
s_mov_b32 s64, 0
s_mov_b32 s63, s79
s_lshl_b32 s85, s78, 11
s_add_u32 s85, s85, 644096
s_lshl_b32 s60, s2, 10
s_add_u32 s60, s60, 147456
s_lshl_b32 s61, s2, 4
s_add_u32 s61, s61, 409600
v_lshrrev_b32 v10, 5, v0
v_lshlrev_b32 v127, 3, v10
v_lshlrev_b32 v126, 8, v0
s_mov_b32 s94, 0
s_mov_b32 s62, 8000000
s_mov_b32 s67, 0
L_srv:
ds_read_b32 v9, v8 offset:9024
ds_read_b32 v10, v8 offset:9040
s_waitcnt lgkmcnt(0)
v_readfirstlane_b32 s58, v9
v_readfirstlane_b32 s59, v10
s_cmp_eq_u32 s58, 4
s_nop 2
s_cbranch_scc1 L_srv_done
s_sub_u32 s69, s59, s84
s_cmp_eq_u32 s69, 0
s_cbranch_scc1 L_srv_idle
s_cmp_lg_u32 s64, 0
s_cbranch_scc1 L_srv_put
s_mov_b32 s59, 1024
s_cmp_lg_u32 s86, 0
s_cbranch_scc1 L_srv_put2
s_cmp_eq_u32 s67, 0
s_cselect_b32 s69, 4, s69
s_lshl_b32 s58, s63, 8
s_add_u32 s58, s58, s85
v_mov_b32 v11, s69
s_mov_b64 exec, 1
buffer_atomic_add v11, v8, s[40:43], s58 offen sc0
s_mov_b64 exec, 0xff
buffer_load_dword v10, v126, s[40:43], s85 offen sc1
s_waitcnt vmcnt(0)
v_readfirstlane_b32 s65, v11
s_nop 0
s_add_u32 s65, s65, 1
s_mov_b32 s66, s63
s_min_u32 s58, s65, 20
s_sub_u32 s58, 20, s58
s_min_u32 s64, s58, s69
s_sub_u32 s58, s58, s64
s_cmp_lt_u32 s58, 0
s_cselect_b32 s67, 1, 0
s_cmp_lg_u32 s58, 0
s_cbranch_scc1 L_srv_keep
v_add_u32 v10, 1, v10
v_mov_b32 v11, 20
v_cmp_eq_u32 vcc, s63, v0
s_nop 1
v_cndmask_b32 v10, v10, v11, vcc
v_min_u32 v10, v10, v11
v_lshl_add_u32 v10, v10, 3, v0
s_nop 1
v_min_u32_dpp v10, v10, v10 quad_perm:[1,0,3,2] row_mask:0xf bank_mask:0xf
s_nop 1
v_min_u32_dpp v10, v10, v10 quad_perm:[2,3,0,1] row_mask:0xf bank_mask:0xf
s_nop 1
v_min_u32_dpp v10, v10, v10 row_half_mirror row_mask:0xf bank_mask:0xf
s_nop 0
v_readfirstlane_b32 s59, v10
s_nop 0
s_and_b32 s63, s59, 7
s_lshr_b32 s59, s59, 3
s_cmp_ge_u32 s59, 20
s_cselect_b32 s86, 1, 0
s_cmp_gt_u32 s59, 20
s_cselect_b32 s67, 1, 0
L_srv_keep:
s_mov_b64 exec, -1
s_cmp_eq_u32 s64, 0
s_cbranch_scc1 L_srv
L_srv_put:
s_add_u32 s58, s65, 108
s_lshr_b32 s59, s58, 2
s_lshl_b32 s59, s59, 5
s_and_b32 s58, s58, 3
s_add_u32 s59, s59, s58
s_lshl_b32 s58, s66, 2
s_add_u32 s59, s59, s58
s_add_u32 s65, s65, 1
s_sub_u32 s64, s64, 1
L_srv_put2:
s_and_b32 s58, s84, 15
s_lshl_b32 s58, s58, 2
s_add_u32 s84, s84, 1
v_mov_b32 v11, s58
v_mov_b32 v9, s59
v_mov_b32 v10, s84
s_mov_b64 exec, 1
ds_write_b32 v11, v9 offset:9056
ds_write_b32 v8, v10 offset:9044
s_mov_b64 exec, -1
s_branch L_srv
L_srv_idle:
s_sleep 2
s_sub_u32 s62, s62, 1
s_cmp_lg_u32 s62, 0
s_cbranch_scc1 L_srv
L_srv_done:
ds_read_b64 v[40:41], v127 offset:8960
ds_read_b64 v[42:43], v127 offset:8976
ds_read_b64 v[44:45], v127 offset:8992
ds_read_b64 v[46:47], v127 offset:9008
ds_read_b128 v[24:27], v6 offset:4864
ds_read_b128 v[28:31], v6 offset:5888
ds_read_b128 v[32:35], v6 offset:6912
ds_read_b128 v[36:39], v6 offset:7936
s_waitcnt lgkmcnt(0)
v_max3_f32 v48, v40, v42, v44
v_max_f32 v48, v48, v46
v_sub_f32 v40, v40, v48
v_mul_f32 v40, s70, v40
v_sub_f32 v42, v42, v48
v_mul_f32 v42, s70, v42
v_sub_f32 v44, v44, v48
v_mul_f32 v44, s70, v44
v_sub_f32 v46, v46, v48
v_mul_f32 v46, s70, v46
v_exp_f32 v40, v40
v_exp_f32 v42, v42
v_exp_f32 v44, v44
v_exp_f32 v46, v46
v_mul_f32 v49, v40, v41
v_mul_f32 v52, v40, v24
v_mul_f32 v53, v40, v25
v_mul_f32 v54, v40, v26
v_mul_f32 v55, v40, v27
v_fmac_f32 v49, v42, v43
v_fmac_f32 v52, v42, v28
v_fmac_f32 v53, v42, v29
v_fmac_f32 v54, v42, v30
v_fmac_f32 v55, v42, v31
v_fmac_f32 v49, v44, v45
v_fmac_f32 v52, v44, v32
v_fmac_f32 v53, v44, v33
v_fmac_f32 v54, v44, v34
v_fmac_f32 v55, v44, v35
v_fmac_f32 v49, v46, v47
v_fmac_f32 v52, v46, v36
v_fmac_f32 v53, v46, v37
v_fmac_f32 v54, v46, v38
v_fmac_f32 v55, v46, v39
v_min_u32 v52, -2, v52
v_min_u32 v53, -2, v53
v_min_u32 v54, -2, v54
v_min_u32 v55, -2, v55
v_min_u32 v48, -2, v48
v_min_u32 v49, -2, v49
buffer_store_dwordx4 v[52:55], v6, s[40:43], s60 offen sc1
s_mov_b32 exec_lo, 1
s_mov_b32 exec_hi, 1
buffer_store_dwordx2 v[48:49], v127, s[40:43], s61 offen sc1
s_mov_b64 exec, -1
s_cmp_eq_u32 s73, 0
s_cbranch_scc1 L_q_nowo
s_mov_b32 s62, 1000000
L_poll_10:
buffer_load_dwordx2 v[56:57], v15, s[40:43], s89 offen offset:0 sc1
buffer_load_dwordx2 v[58:59], v15, s[40:43], s89 offen offset:16 sc1
buffer_load_dwordx2 v[60:61], v15, s[40:43], s89 offen offset:32 sc1
buffer_load_dwordx2 v[62:63], v15, s[40:43], s89 offen offset:48 sc1
buffer_load_dwordx2 v[64:65], v15, s[40:43], s89 offen offset:64 sc1
buffer_load_dwordx2 v[66:67], v15, s[40:43], s89 offen offset:80 sc1
buffer_load_dwordx2 v[68:69], v15, s[40:43], s89 offen offset:96 sc1
buffer_load_dwordx2 v[70:71], v15, s[40:43], s89 offen offset:112 sc1
buffer_load_dwordx4 v[24:27], v14, s[40:43], s87 offen offset:0 sc1
buffer_load_dwordx4 v[28:31], v14, s[40:43], s87 offen offset:1024 sc1
buffer_load_dwordx4 v[32:35], v14, s[40:43], s87 offen offset:2048 sc1
buffer_load_dwordx4 v[36:39], v14, s[40:43], s87 offen offset:3072 sc1
buffer_load_dwordx4 v[40:43], v14, s[40:43], s88 offen offset:0 sc1
buffer_load_dwordx4 v[44:47], v14, s[40:43], s88 offen offset:1024 sc1
buffer_load_dwordx4 v[48:51], v14, s[40:43], s88 offen offset:2048 sc1
buffer_load_dwordx4 v[52:55], v14, s[40:43], s88 offen offset:3072 sc1
s_waitcnt vmcnt(0)
v_max3_u32 v9, v24, v25, v26
v_max3_u32 v9, v9, v27, v28
v_max3_u32 v9, v9, v29, v30
v_max3_u32 v9, v9, v31, v32
v_max3_u32 v9, v9, v33, v34
v_max3_u32 v9, v9, v35, v36
v_max3_u32 v9, v9, v37, v38
v_max3_u32 v9, v9, v39, v40
v_max3_u32 v9, v9, v41, v42
v_max3_u32 v9, v9, v43, v44
v_max3_u32 v9, v9, v45, v46
v_max3_u32 v9, v9, v47, v48
v_max3_u32 v9, v9, v49, v50
v_max3_u32 v9, v9, v51, v52
v_max3_u32 v9, v9, v53, v54
v_max3_u32 v9, v9, v55, v56
v_max3_u32 v9, v9, v57, v58
v_max3_u32 v9, v9, v59, v60
v_max3_u32 v9, v9, v61, v62
v_max3_u32 v9, v9, v63, v64
v_max3_u32 v9, v9, v65, v66
v_max3_u32 v9, v9, v67, v68
v_max3_u32 v9, v9, v69, v70
v_max_u32 v9, v9, v71
v_cmp_eq_u32 vcc, -1, v9
s_nop 3
s_cbranch_vccz L_polld_11
s_sleep 1
s_sub_u32 s62, s62, 1
s_cmp_lg_u32 s62, 0
s_cbranch_scc1 L_poll_10
L_polld_11:
v_max3_f32 v120, v56, v58, v60
v_max3_f32 v120, v120, v62, v64
v_max3_f32 v120, v120, v66, v68
v_max_f32 v120, v120, v70
v_sub_f32 v56, v56, v120
v_mul_f32 v56, s70, v56
v_sub_f32 v58, v58, v120
v_mul_f32 v58, s70, v58
v_sub_f32 v60, v60, v120
v_mul_f32 v60, s70, v60
v_sub_f32 v62, v62, v120
v_mul_f32 v62, s70, v62
v_sub_f32 v64, v64, v120
v_mul_f32 v64, s70, v64
v_sub_f32 v66, v66, v120
v_mul_f32 v66, s70, v66
v_sub_f32 v68, v68, v120
v_mul_f32 v68, s70, v68
v_sub_f32 v70, v70, v120
v_mul_f32 v70, s70, v70
v_exp_f32 v56, v56
v_exp_f32 v58, v58
v_exp_f32 v60, v60
v_exp_f32 v62, v62
v_exp_f32 v64, v64
v_exp_f32 v66, v66
v_exp_f32 v68, v68
v_exp_f32 v70, v70
v_mul_f32 v121, v56, v57
v_mul_f32 v124, v56, v24
v_mul_f32 v125, v56, v25
v_mul_f32 v126, v56, v26
v_mul_f32 v127, v56, v27
v_fmac_f32 v121, v58, v59
v_fmac_f32 v124, v58, v28
v_fmac_f32 v125, v58, v29
v_fmac_f32 v126, v58, v30
v_fmac_f32 v127, v58, v31
v_fmac_f32 v121, v60, v61
v_fmac_f32 v124, v60, v32
v_fmac_f32 v125, v60, v33
v_fmac_f32 v126, v60, v34
v_fmac_f32 v127, v60, v35
v_fmac_f32 v121, v62, v63
v_fmac_f32 v124, v62, v36
v_fmac_f32 v125, v62, v37
v_fmac_f32 v126, v62, v38
v_fmac_f32 v127, v62, v39
v_fmac_f32 v121, v64, v65
v_fmac_f32 v124, v64, v40
v_fmac_f32 v125, v64, v41
v_fmac_f32 v126, v64, v42
v_fmac_f32 v127, v64, v43
v_fmac_f32 v121, v66, v67
v_fmac_f32 v124, v66, v44
v_fmac_f32 v125, v66, v45
v_fmac_f32 v126, v66, v46
v_fmac_f32 v127, v66, v47
v_fmac_f32 v121, v68, v69
v_fmac_f32 v124, v68, v48
v_fmac_f32 v125, v68, v49
v_fmac_f32 v126, v68, v50
v_fmac_f32 v127, v68, v51
v_fmac_f32 v121, v70, v71
v_fmac_f32 v124, v70, v52
v_fmac_f32 v125, v70, v53
v_fmac_f32 v126, v70, v54
v_fmac_f32 v127, v70, v55
v_rcp_f32 v9, v121
s_nop 0
v_mul_f32 v10, v124, v9
v_fma_f32 v11, -v10, v121, v124
v_fma_f32 v124, v11, v9, v10
v_mul_f32 v10, v125, v9
v_fma_f32 v11, -v10, v121, v125
v_fma_f32 v125, v11, v9, v10
v_mul_f32 v10, v126, v9
v_fma_f32 v11, -v10, v121, v126
v_fma_f32 v126, v11, v9, v10
v_mul_f32 v10, v127, v9
v_fma_f32 v11, -v10, v121, v127
v_fma_f32 v127, v11, v9, v10
v_cvt_pk_bf16_f32 v122, v124, v125
v_cvt_pk_bf16_f32 v123, v126, v127
ds_write_b64 v13, v[122:123] offset:3840
ds_read_b128 v[24:27], v12 offset:3840
ds_read_b128 v[28:31], v12 offset:3904
ds_read_b128 v[32:35], v12 offset:3968
ds_read_b128 v[36:39], v12 offset:4032
s_waitcnt lgkmcnt(3)
v_mfma_f32_16x16x32_bf16 v[40:43], v[24:27], v[192:195], 0
v_mfma_f32_16x16x32_bf16 v[44:47], v[24:27], v[196:199], 0
v_mfma_f32_16x16x32_bf16 v[48:51], v[24:27], v[200:203], 0
v_mfma_f32_16x16x32_bf16 v[52:55], v[24:27], v[204:207], 0
s_waitcnt lgkmcnt(2)
v_mfma_f32_16x16x32_bf16 v[40:43], v[28:31], v[208:211], v[40:43]
v_mfma_f32_16x16x32_bf16 v[44:47], v[28:31], v[212:215], v[44:47]
v_mfma_f32_16x16x32_bf16 v[48:51], v[28:31], v[216:219], v[48:51]
v_mfma_f32_16x16x32_bf16 v[52:55], v[28:31], v[220:223], v[52:55]
s_waitcnt lgkmcnt(1)
v_mfma_f32_16x16x32_bf16 v[40:43], v[32:35], v[224:227], v[40:43]
v_mfma_f32_16x16x32_bf16 v[44:47], v[32:35], v[228:231], v[44:47]
v_mfma_f32_16x16x32_bf16 v[48:51], v[32:35], v[232:235], v[48:51]
v_mfma_f32_16x16x32_bf16 v[52:55], v[32:35], v[236:239], v[52:55]
s_waitcnt lgkmcnt(0)
v_mfma_f32_16x16x32_bf16 v[40:43], v[36:39], v[240:243], v[40:43]
v_mfma_f32_16x16x32_bf16 v[44:47], v[36:39], v[244:247], v[44:47]
v_mfma_f32_16x16x32_bf16 v[48:51], v[36:39], v[248:251], v[48:51]
v_mfma_f32_16x16x32_bf16 v[52:55], v[36:39], v[252:255], v[52:55]
s_mov_b64 exec, 0xffff
s_nop 3
v_min_u32 v40, -2, v40
v_min_u32 v41, -2, v41
buffer_store_dwordx2 v[40:41], v5, s[40:43], s68 offen offset:0 sc1
v_min_u32 v44, -2, v44
v_min_u32 v45, -2, v45
buffer_store_dwordx2 v[44:45], v5, s[40:43], s68 offen offset:128 sc1
v_min_u32 v48, -2, v48
v_min_u32 v49, -2, v49
buffer_store_dwordx2 v[48:49], v5, s[40:43], s68 offen offset:256 sc1
v_min_u32 v52, -2, v52
v_min_u32 v53, -2, v53
buffer_store_dwordx2 v[52:53], v5, s[40:43], s68 offen offset:384 sc1
s_mov_b64 exec, -1
L_q_exit:
s_endpgm
L_q_nowo:
s_cmp_eq_u32 s71, 0
s_cbranch_scc1 L_q_exit
s_mov_b32 s48, s34
s_and_b32 s49, s35, 0xffff
s_mov_b32 s50, 2304
s_mov_b32 s51, 0x20000
s_cmp_lg_u32 s94, 0
s_cselect_b32 s50, 0, 2304
s_add_u32 s59, s80, 4096
s_add_u32 s60, s80, 8192
s_add_u32 s61, s80, 12288
s_mov_b32 s58, s80
v_bfe_u32 v10, v0, 3, 2
v_and_b32 v11, 7, v0
v_lshlrev_b32 v11, 1, v11
v_lshl_add_u32 v11, v10, 4, v11
v_lshlrev_b32 v12, 1, v11
v_lshlrev_b32 v11, 2, v11
s_cmp_lg_u32 s94, 0
s_cbranch_scc1 L_fin_nowait
s_mov_b32 s62, 8000000
L_ld_12:
ds_read_b32 v9, v8 offset:9048
s_waitcnt lgkmcnt(0)
v_cmp_ne_u32 vcc, 1, v9
s_nop 3
s_cbranch_vccz L_ldd_13
s_sleep 1
s_sub_u32 s62, s62, 1
s_cmp_lg_u32 s62, 0
s_cbranch_scc1 L_ld_12
L_ldd_13:
L_fin_nowait:
ds_read_b64 v[24:25], v11 offset:2816
ds_read_b64 v[26:27], v11 offset:3072
ds_read_b64 v[28:29], v11 offset:3328
ds_read_b64 v[30:31], v11 offset:3584
s_mov_b32 s62, 1000000
L_poll_14:
buffer_load_dwordx4 v[128:131], v6, s[40:43], s58 offen offset:0 sc1
buffer_load_dwordx4 v[132:135], v6, s[40:43], s58 offen offset:1024 sc1
buffer_load_dwordx4 v[136:139], v6, s[40:43], s58 offen offset:2048 sc1
buffer_load_dwordx4 v[140:143], v6, s[40:43], s58 offen offset:3072 sc1
buffer_load_dwordx4 v[144:147], v6, s[40:43], s59 offen offset:0 sc1
buffer_load_dwordx4 v[148:151], v6, s[40:43], s59 offen offset:1024 sc1
buffer_load_dwordx4 v[152:155], v6, s[40:43], s59 offen offset:2048 sc1
buffer_load_dwordx4 v[156:159], v6, s[40:43], s59 offen offset:3072 sc1
buffer_load_dwordx4 v[160:163], v6, s[40:43], s60 offen offset:0 sc1
buffer_load_dwordx4 v[164:167], v6, s[40:43], s60 offen offset:1024 sc1
buffer_load_dwordx4 v[168:171], v6, s[40:43], s60 offen offset:2048 sc1
buffer_load_dwordx4 v[172:175], v6, s[40:43], s60 offen offset:3072 sc1
buffer_load_dwordx4 v[176:179], v6, s[40:43], s61 offen offset:0 sc1
buffer_load_dwordx4 v[180:183], v6, s[40:43], s61 offen offset:1024 sc1
buffer_load_dwordx4 v[184:187], v6, s[40:43], s61 offen offset:2048 sc1
buffer_load_dwordx4 v[188:191], v6, s[40:43], s61 offen offset:3072 sc1
s_waitcnt vmcnt(0)
v_max3_u32 v9, v128, v129, v130
v_max3_u32 v9, v9, v131, v132
v_max3_u32 v9, v9, v133, v134
v_max3_u32 v9, v9, v135, v136
v_max3_u32 v9, v9, v137, v138
v_max3_u32 v9, v9, v139, v140
v_max3_u32 v9, v9, v141, v142
v_max3_u32 v9, v9, v143, v144
v_max3_u32 v9, v9, v145, v146
v_max3_u32 v9, v9, v147, v148
v_max3_u32 v9, v9, v149, v150
v_max3_u32 v9, v9, v151, v152
v_max3_u32 v9, v9, v153, v154
v_max3_u32 v9, v9, v155, v156
v_max3_u32 v9, v9, v157, v158
v_max3_u32 v9, v9, v159, v160
v_max3_u32 v9, v9, v161, v162
v_max3_u32 v9, v9, v163, v164
v_max3_u32 v9, v9, v165, v166
v_max3_u32 v9, v9, v167, v168
v_max3_u32 v9, v9, v169, v170
v_max3_u32 v9, v9, v171, v172
v_max3_u32 v9, v9, v173, v174
v_max3_u32 v9, v9, v175, v176
v_max3_u32 v9, v9, v177, v178
v_max3_u32 v9, v9, v179, v180
v_max3_u32 v9, v9, v181, v182
v_max3_u32 v9, v9, v183, v184
v_max3_u32 v9, v9, v185, v186
v_max3_u32 v9, v9, v187, v188
v_max3_u32 v9, v9, v189, v190
v_max_u32 v9, v9, v191
v_cmp_eq_u32 vcc, -1, v9
s_nop 3
s_cbranch_vccz L_polld_15
s_sleep 1
s_sub_u32 s62, s62, 1
s_cmp_lg_u32 s62, 0
s_cbranch_scc1 L_poll_14
L_polld_15:
v_add_f32 v128, v128, v132
v_add_f32 v129, v129, v133
v_add_f32 v130, v130, v134
v_add_f32 v131, v131, v135
v_add_f32 v136, v136, v140
v_add_f32 v137, v137, v141
v_add_f32 v138, v138, v142
v_add_f32 v139, v139, v143
v_add_f32 v144, v144, v148
v_add_f32 v145, v145, v149
v_add_f32 v146, v146, v150
v_add_f32 v147, v147, v151
v_add_f32 v152, v152, v156
v_add_f32 v153, v153, v157
v_add_f32 v154, v154, v158
v_add_f32 v155, v155, v159
v_add_f32 v160, v160, v164
v_add_f32 v161, v161, v165
v_add_f32 v162, v162, v166
v_add_f32 v163, v163, v167
v_add_f32 v168, v168, v172
v_add_f32 v169, v169, v173
v_add_f32 v170, v170, v174
v_add_f32 v171, v171, v175
v_add_f32 v176, v176, v180
v_add_f32 v177, v177, v181
v_add_f32 v178, v178, v182
v_add_f32 v179, v179, v183
v_add_f32 v184, v184, v188
v_add_f32 v185, v185, v189
v_add_f32 v186, v186, v190
v_add_f32 v187, v187, v191
v_add_f32 v128, v128, v136
v_add_f32 v129, v129, v137
v_add_f32 v130, v130, v138
v_add_f32 v131, v131, v139
v_add_f32 v144, v144, v152
v_add_f32 v145, v145, v153
v_add_f32 v146, v146, v154
v_add_f32 v147, v147, v155
v_add_f32 v160, v160, v168
v_add_f32 v161, v161, v169
v_add_f32 v162, v162, v170
v_add_f32 v163, v163, v171
v_add_f32 v176, v176, v184
v_add_f32 v177, v177, v185
v_add_f32 v178, v178, v186
v_add_f32 v179, v179, v187
v_add_f32 v128, v128, v144
v_add_f32 v129, v129, v145
v_add_f32 v130, v130, v146
v_add_f32 v131, v131, v147
v_add_f32 v160, v160, v176
v_add_f32 v161, v161, v177
v_add_f32 v162, v162, v178
v_add_f32 v163, v163, v179
v_add_f32 v128, v128, v160
v_add_f32 v129, v129, v161
v_add_f32 v130, v130, v162
v_add_f32 v131, v131, v163
v_mov_b32 v132, v128
v_mov_b32 v133, v129
v_mov_b32 v134, v130
v_mov_b32 v135, v131
v_permlane32_swap_b32 v132, v128
v_permlane32_swap_b32 v133, v129
v_permlane32_swap_b32 v134, v130
v_permlane32_swap_b32 v135, v131
v_add_f32 v128, v128, v132
v_add_f32 v129, v129, v133
v_add_f32 v130, v130, v134
v_add_f32 v131, v131, v135
s_waitcnt lgkmcnt(0)
v_cvt_pk_bf16_f32 v128, v128, v128
v_lshlrev_b32 v128, 16, v128
v_add_f32 v128, v28, v128
v_cvt_pk_bf16_f32 v128, v128, v128
v_lshlrev_b32 v128, 16, v128
v_add_f32 v128, v128, v24
v_cvt_pk_bf16_f32 v129, v129, v129
v_lshlrev_b32 v129, 16, v129
v_add_f32 v129, v30, v129
v_cvt_pk_bf16_f32 v129, v129, v129
v_lshlrev_b32 v129, 16, v129
v_add_f32 v129, v129, v26
v_cvt_pk_bf16_f32 v130, v130, v130
v_lshlrev_b32 v130, 16, v130
v_add_f32 v130, v29, v130
v_cvt_pk_bf16_f32 v130, v130, v130
v_lshlrev_b32 v130, 16, v130
v_add_f32 v130, v130, v25
v_cvt_pk_bf16_f32 v131, v131, v131
v_lshlrev_b32 v131, 16, v131
v_add_f32 v131, v31, v131
v_cvt_pk_bf16_f32 v131, v131, v131
v_lshlrev_b32 v131, 16, v131
v_add_f32 v131, v131, v27
v_cvt_pk_bf16_f32 v132, v128, v130
v_cvt_pk_bf16_f32 v133, v129, v131
s_mov_b32 exec_hi, 0
buffer_store_dword v132, v12, s[48:51], s81 offen
buffer_store_dword v133, v12, s[48:51], s81 offen offset:1152
s_mov_b64 exec, -1
s_cmp_lg_u32 s2, 7
s_cbranch_scc1 L_q_exit
v_mov_b32 v12, s82
v_mov_b32 v13, s83
s_mov_b32 s58, 983040
s_mov_b64 exec, 1
buffer_store_dwordx2 v[12:13], v8, s[40:43], s58 offen
s_branch L_q_exit
L_auxf:
s_setprio 2
s_cmp_ge_u32 s2, 32
s_cbranch_scc1 L_noclr_16
v_lshlrev_b32 v6, 4, v0
v_mov_b32 v40, -1
v_mov_b32 v41, -1
v_mov_b32 v42, -1
v_mov_b32 v43, -1
s_mul_i32 s58, s2, 22528
buffer_store_dwordx4 v[40:43], v6, s[40:43], s58 offen offset:0 sc1
buffer_store_dwordx4 v[40:43], v6, s[40:43], s58 offen offset:1024 sc1
buffer_store_dwordx4 v[40:43], v6, s[40:43], s58 offen offset:2048 sc1
buffer_store_dwordx4 v[40:43], v6, s[40:43], s58 offen offset:3072 sc1
s_add_u32 s58, s58, 4096
buffer_store_dwordx4 v[40:43], v6, s[40:43], s58 offen offset:0 sc1
buffer_store_dwordx4 v[40:43], v6, s[40:43], s58 offen offset:1024 sc1
buffer_store_dwordx4 v[40:43], v6, s[40:43], s58 offen offset:2048 sc1
buffer_store_dwordx4 v[40:43], v6, s[40:43], s58 offen offset:3072 sc1
s_add_u32 s58, s58, 4096
buffer_store_dwordx4 v[40:43], v6, s[40:43], s58 offen offset:0 sc1
buffer_store_dwordx4 v[40:43], v6, s[40:43], s58 offen offset:1024 sc1
buffer_store_dwordx4 v[40:43], v6, s[40:43], s58 offen offset:2048 sc1
buffer_store_dwordx4 v[40:43], v6, s[40:43], s58 offen offset:3072 sc1
s_add_u32 s58, s58, 4096
buffer_store_dwordx4 v[40:43], v6, s[40:43], s58 offen offset:0 sc1
buffer_store_dwordx4 v[40:43], v6, s[40:43], s58 offen offset:1024 sc1
buffer_store_dwordx4 v[40:43], v6, s[40:43], s58 offen offset:2048 sc1
buffer_store_dwordx4 v[40:43], v6, s[40:43], s58 offen offset:3072 sc1
s_add_u32 s58, s58, 4096
buffer_store_dwordx4 v[40:43], v6, s[40:43], s58 offen offset:0 sc1
buffer_store_dwordx4 v[40:43], v6, s[40:43], s58 offen offset:1024 sc1
buffer_store_dwordx4 v[40:43], v6, s[40:43], s58 offen offset:2048 sc1
buffer_store_dwordx4 v[40:43], v6, s[40:43], s58 offen offset:3072 sc1
s_add_u32 s58, s58, 4096
buffer_store_dwordx4 v[40:43], v6, s[40:43], s58 offen offset:0 sc1
buffer_store_dwordx4 v[40:43], v6, s[40:43], s58 offen offset:1024 sc1
s_nop 1
L_noclr_16:
s_barrier
v_lshrrev_b32 v1, 3, v0
v_and_b32 v2, 7, v0
v_lshlrev_b32 v2, 4, v2
v_mov_b32 v8, 0
s_mov_b32 s52, s36
s_and_b32 s53, s37, 0xffff
s_mov_b32 s54, 256
s_mov_b32 s55, 0x20000
s_cmp_ge_u32 s2, 32
s_cbranch_scc1 L_noagent_17
v_mov_b32 v9, 1
s_waitcnt vmcnt(0)
s_mov_b64 exec, 1
buffer_atomic_add v9, v8, s[52:55], 0 offen sc0
s_waitcnt vmcnt(0)
v_cmp_eq_u32 vcc, 31, v9
s_mov_b64 exec, -1
s_nop 2
s_cbranch_vccz L_noagent_17
v_mov_b32 v9, 1
s_mov_b64 exec, 1
buffer_store_dword v9, v8, s[52:55], 0 offen offset:128 sc1
s_mov_b64 exec, -1
L_noagent_17:
s_lshr_b32 s58, s2, 3
s_and_b32 s59, s2, 7
s_mul_i32 s66, s58, 9
s_add_u32 s66, s66, s59
v_mul_u32_u24 v3, 9216, v1
v_add_u32 v3, v3, v2
s_cmp_lt_u32 s66, 144
s_cselect_b32 s44, s28, s30
s_cselect_b32 s45, s29, s31
s_cselect_b32 s58, 0, 144
s_and_b32 s45, s45, 0xffff
s_mov_b32 s46, 5308416
s_mov_b32 s47, 0x20000
s_sub_u32 s58, s66, s58
s_and_b32 s59, s58, 1
s_lshr_b32 s58, s58, 1
s_lshl_b32 s69, s58, 7
s_mul_i32 s58, s59, 2654208
s_add_u32 s69, s69, s58
s_mul_i32 s61, s59, 576
buffer_load_dwordx4 v[128:131], v3, s[44:47], s69 offen nt
s_add_u32 s69, s69, 73728
buffer_load_dwordx4 v[132:135], v3, s[44:47], s69 offen nt
s_add_u32 s69, s69, 73728
buffer_load_dwordx4 v[136:139], v3, s[44:47], s69 offen nt
s_add_u32 s69, s69, 73728
buffer_load_dwordx4 v[140:143], v3, s[44:47], s69 offen nt
s_add_u32 s69, s69, 73728
buffer_load_dwordx4 v[144:147], v3, s[44:47], s69 offen nt
s_add_u32 s69, s69, 73728
buffer_load_dwordx4 v[148:151], v3, s[44:47], s69 offen nt
s_add_u32 s69, s69, 73728
buffer_load_dwordx4 v[152:155], v3, s[44:47], s69 offen nt
s_add_u32 s69, s69, 73728
buffer_load_dwordx4 v[156:159], v3, s[44:47], s69 offen nt
s_add_u32 s69, s69, 73728
buffer_load_dwordx4 v[160:163], v3, s[44:47], s69 offen nt
s_add_u32 s69, s69, 73728
buffer_load_dwordx4 v[164:167], v3, s[44:47], s69 offen nt
s_add_u32 s69, s69, 73728
buffer_load_dwordx4 v[168:171], v3, s[44:47], s69 offen nt
s_add_u32 s69, s69, 73728
buffer_load_dwordx4 v[172:175], v3, s[44:47], s69 offen nt
s_add_u32 s69, s69, 73728
buffer_load_dwordx4 v[176:179], v3, s[44:47], s69 offen nt
s_add_u32 s69, s69, 73728
buffer_load_dwordx4 v[180:183], v3, s[44:47], s69 offen nt
s_add_u32 s69, s69, 73728
buffer_load_dwordx4 v[184:187], v3, s[44:47], s69 offen nt
s_add_u32 s69, s69, 73728
buffer_load_dwordx4 v[188:191], v3, s[44:47], s69 offen nt
s_add_u32 s69, s69, 73728
buffer_load_dwordx4 v[192:195], v3, s[44:47], s69 offen nt
s_add_u32 s69, s69, 73728
buffer_load_dwordx4 v[196:199], v3, s[44:47], s69 offen nt
s_add_u32 s69, s69, 73728
buffer_load_dwordx4 v[200:203], v3, s[44:47], s69 offen nt
s_add_u32 s69, s69, 73728
buffer_load_dwordx4 v[204:207], v3, s[44:47], s69 offen nt
s_add_u32 s69, s69, 73728
buffer_load_dwordx4 v[208:211], v3, s[44:47], s69 offen nt
s_add_u32 s69, s69, 73728
buffer_load_dwordx4 v[212:215], v3, s[44:47], s69 offen nt
s_add_u32 s69, s69, 73728
buffer_load_dwordx4 v[216:219], v3, s[44:47], s69 offen nt
s_add_u32 s69, s69, 73728
buffer_load_dwordx4 v[220:223], v3, s[44:47], s69 offen nt
s_add_u32 s69, s69, 73728
buffer_load_dwordx4 v[224:227], v3, s[44:47], s69 offen nt
s_add_u32 s69, s69, 73728
buffer_load_dwordx4 v[228:231], v3, s[44:47], s69 offen nt
s_add_u32 s69, s69, 73728
buffer_load_dwordx4 v[232:235], v3, s[44:47], s69 offen nt
s_add_u32 s69, s69, 73728
buffer_load_dwordx4 v[236:239], v3, s[44:47], s69 offen nt
s_add_u32 s69, s69, 73728
buffer_load_dwordx4 v[240:243], v3, s[44:47], s69 offen nt
s_add_u32 s69, s69, 73728
buffer_load_dwordx4 v[244:247], v3, s[44:47], s69 offen nt
s_add_u32 s69, s69, 73728
buffer_load_dwordx4 v[248:251], v3, s[44:47], s69 offen nt
s_add_u32 s69, s69, 73728
buffer_load_dwordx4 v[252:255], v3, s[44:47], s69 offen nt
s_add_u32 s69, s69, 73728
buffer_load_dwordx4 v[84:87], v3, s[44:47], s69 offen nt
s_add_u32 s69, s69, 73728
buffer_load_dwordx4 v[88:91], v3, s[44:47], s69 offen nt
s_add_u32 s69, s69, 73728
buffer_load_dwordx4 v[92:95], v3, s[44:47], s69 offen nt
s_add_u32 s69, s69, 73728
buffer_load_dwordx4 v[96:99], v3, s[44:47], s69 offen nt
v_lshlrev_b32 v6, 4, v0
s_mov_b32 s56, 0x00ff00ff
s_mov_b32 s57, 0x00ff00ff
s_mov_b32 s70, 0x3fb8aa3b
v_lshrrev_b32 v9, 5, v0
v_lshlrev_b32 v5, 8, v9
v_lshl_add_u32 v5, v2, 1, v5
v_bfe_u32 v9, v0, 4, 1
v_lshl_add_u32 v5, v9, 4, v5
v_bfe_u32 v7, v0, 3, 1
v_lshrrev_b32 v9, 4, v0
v_lshlrev_b32 v4, 2, v9
v_and_b32 v9, 1, v0
v_cmp_eq_u32 vcc, 1, v9
v_mov_b32 v10, 0x01000c0c
v_mov_b32 v11, 0x0c0c0100
v_cndmask_b32 v10, v11, v10, vcc
v_mov_b32 v12, 0x03020c0c
v_mov_b32 v11, 0x0c0c0302
v_cndmask_b32 v12, v11, v12, vcc
v_mov_b32 v11, 0x0c0c0c0c
v_bfe_u32 v9, v0, 1, 2
v_cmp_eq_u32 vcc, 0, v9
s_nop 1
v_cndmask_b32 v16, v11, v10, vcc
v_cndmask_b32 v20, v11, v12, vcc
v_cmp_eq_u32 vcc, 1, v9
s_nop 1
v_cndmask_b32 v17, v11, v10, vcc
v_cndmask_b32 v21, v11, v12, vcc
v_cmp_eq_u32 vcc, 2, v9
s_nop 1
v_cndmask_b32 v18, v11, v10, vcc
v_cndmask_b32 v22, v11, v12, vcc
v_cmp_eq_u32 vcc, 3, v9
s_nop 1
v_cndmask_b32 v19, v11, v10, vcc
v_cndmask_b32 v23, v11, v12, vcc
s_lshr_b32 s78, s2, 3
s_and_b32 s79, s2, 7
s_lshl_b32 s58, s79, 5
s_add_u32 s58, s58, s78
s_cmp_lt_u32 s58, 144
s_cselect_b32 s73, 1, 0
s_mul_i32 s76, s58, 57
s_lshr_b32 s76, s76, 9
s_mul_i32 s77, s76, 9
s_sub_u32 s77, s58, s77
s_mul_i32 s59, s77, 50
s_lshl_b32 s60, s76, 1
s_add_u32 s59, s59, s60
s_lshl_b32 s59, s59, 9
s_add_u32 s68, s59, 413696
s_cmp_eq_u32 s79, 7
s_cselect_b32 s71, 1, 0
s_cmp_lt_u32 s2, 72
s_cselect_b32 s71, s71, 0
s_lshl_b32 s81, s78, 7
s_mul_i32 s80, s78, 25600
s_add_u32 s80, s80, 413696
s_sub_u32 s58, 255, s58
s_cmp_lt_u32 s58, 162
s_cselect_b32 s72, 1, 0
s_mul_i32 s74, s58, 57
s_lshr_b32 s74, s74, 9
s_mul_i32 s75, s74, 9
s_sub_u32 s75, s58, s75
s_mul_i32 s59, s75, 50
s_add_u32 s59, s59, s74
s_lshl_b32 s59, s59, 9
s_add_u32 s67, s59, 430080
v_mul_u32_u24 v14, 1152, v7
v_add_u32 v14, v14, v4
v_add_u32 v15, s61, v14
s_mov_b32 s62, 8000000
s_nop 0
L_ld_18:
ds_read_b32 v9, v8 offset:9032
s_waitcnt lgkmcnt(0)
v_cmp_ne_u32 vcc, 1, v9
s_nop 3
s_cbranch_vccz L_ldd_19
s_sleep 2
s_sub_u32 s62, s62, 1
s_cmp_lg_u32 s62, 0
s_cbranch_scc1 L_ld_18
L_ldd_19:
s_waitcnt vmcnt(0)
ds_read_b32 v48, v15 offset:0
ds_read_b32 v49, v15 offset:16
ds_read_b32 v50, v15 offset:32
ds_read_b32 v51, v15 offset:48
ds_read_b32 v52, v15 offset:64
ds_read_b32 v53, v15 offset:80
ds_read_b32 v54, v15 offset:96
ds_read_b32 v55, v15 offset:112
ds_read_b32 v56, v15 offset:128
ds_read_b32 v57, v15 offset:144
ds_read_b32 v58, v15 offset:160
ds_read_b32 v59, v15 offset:176
ds_read_b32 v60, v15 offset:192
ds_read_b32 v61, v15 offset:208
ds_read_b32 v62, v15 offset:224
ds_read_b32 v63, v15 offset:240
ds_read_b32 v64, v15 offset:256
ds_read_b32 v65, v15 offset:272
ds_read_b32 v66, v15 offset:288
ds_read_b32 v67, v15 offset:304
ds_read_b32 v68, v15 offset:320
ds_read_b32 v69, v15 offset:336
ds_read_b32 v70, v15 offset:352
ds_read_b32 v71, v15 offset:368
ds_read_b32 v72, v15 offset:384
ds_read_b32 v73, v15 offset:400
ds_read_b32 v74, v15 offset:416
ds_read_b32 v75, v15 offset:432
ds_read_b32 v76, v15 offset:448
ds_read_b32 v77, v15 offset:464
ds_read_b32 v78, v15 offset:480
ds_read_b32 v79, v15 offset:496
ds_read_b32 v80, v15 offset:512
ds_read_b32 v81, v15 offset:528
ds_read_b32 v82, v15 offset:544
ds_read_b32 v83, v15 offset:560
s_waitcnt lgkmcnt(15)
v_perm_b32 v24, v48, v48, v16
v_perm_b32 v25, v48, v48, v17
v_perm_b32 v26, v48, v48, v18
v_perm_b32 v27, v48, v48, v19
v_perm_b32 v28, v48, v48, v20
v_perm_b32 v29, v48, v48, v21
v_perm_b32 v30, v48, v48, v22
v_perm_b32 v31, v48, v48, v23
s_waitcnt lgkmcnt(15)
v_perm_b32 v32, v49, v49, v16
v_perm_b32 v33, v49, v49, v17
v_perm_b32 v34, v49, v49, v18
v_perm_b32 v35, v49, v49, v19
v_perm_b32 v36, v49, v49, v20
v_perm_b32 v37, v49, v49, v21
v_perm_b32 v38, v49, v49, v22
v_perm_b32 v39, v49, v49, v23
v_mfma_f32_16x16x32_bf16 v[40:43], v[24:27], v[128:131], 0
v_mfma_f32_16x16x32_bf16 v[44:47], v[28:31], v[128:131], 0
v_perm_b32 v24, v50, v50, v16
v_perm_b32 v25, v50, v50, v17
v_perm_b32 v26, v50, v50, v18
v_perm_b32 v27, v50, v50, v19
v_perm_b32 v28, v50, v50, v20
v_perm_b32 v29, v50, v50, v21
v_perm_b32 v30, v50, v50, v22
v_perm_b32 v31, v50, v50, v23
v_mfma_f32_16x16x32_bf16 v[40:43], v[32:35], v[132:135], v[40:43]
v_mfma_f32_16x16x32_bf16 v[44:47], v[36:39], v[132:135], v[44:47]
v_perm_b32 v32, v51, v51, v16
v_perm_b32 v33, v51, v51, v17
v_perm_b32 v34, v51, v51, v18
v_perm_b32 v35, v51, v51, v19
v_perm_b32 v36, v51, v51, v20
v_perm_b32 v37, v51, v51, v21
v_perm_b32 v38, v51, v51, v22
v_perm_b32 v39, v51, v51, v23
v_mfma_f32_16x16x32_bf16 v[40:43], v[24:27], v[136:139], v[40:43]
v_mfma_f32_16x16x32_bf16 v[44:47], v[28:31], v[136:139], v[44:47]
v_perm_b32 v24, v52, v52, v16
v_perm_b32 v25, v52, v52, v17
v_perm_b32 v26, v52, v52, v18
v_perm_b32 v27, v52, v52, v19
v_perm_b32 v28, v52, v52, v20
v_perm_b32 v29, v52, v52, v21
v_perm_b32 v30, v52, v52, v22
v_perm_b32 v31, v52, v52, v23
v_mfma_f32_16x16x32_bf16 v[40:43], v[32:35], v[140:143], v[40:43]
v_mfma_f32_16x16x32_bf16 v[44:47], v[36:39], v[140:143], v[44:47]
v_perm_b32 v32, v53, v53, v16
v_perm_b32 v33, v53, v53, v17
v_perm_b32 v34, v53, v53, v18
v_perm_b32 v35, v53, v53, v19
v_perm_b32 v36, v53, v53, v20
v_perm_b32 v37, v53, v53, v21
v_perm_b32 v38, v53, v53, v22
v_perm_b32 v39, v53, v53, v23
v_mfma_f32_16x16x32_bf16 v[40:43], v[24:27], v[144:147], v[40:43]
v_mfma_f32_16x16x32_bf16 v[44:47], v[28:31], v[144:147], v[44:47]
v_perm_b32 v24, v54, v54, v16
v_perm_b32 v25, v54, v54, v17
v_perm_b32 v26, v54, v54, v18
v_perm_b32 v27, v54, v54, v19
v_perm_b32 v28, v54, v54, v20
v_perm_b32 v29, v54, v54, v21
v_perm_b32 v30, v54, v54, v22
v_perm_b32 v31, v54, v54, v23
v_mfma_f32_16x16x32_bf16 v[40:43], v[32:35], v[148:151], v[40:43]
v_mfma_f32_16x16x32_bf16 v[44:47], v[36:39], v[148:151], v[44:47]
v_perm_b32 v32, v55, v55, v16
v_perm_b32 v33, v55, v55, v17
v_perm_b32 v34, v55, v55, v18
v_perm_b32 v35, v55, v55, v19
v_perm_b32 v36, v55, v55, v20
v_perm_b32 v37, v55, v55, v21
v_perm_b32 v38, v55, v55, v22
v_perm_b32 v39, v55, v55, v23
v_mfma_f32_16x16x32_bf16 v[40:43], v[24:27], v[152:155], v[40:43]
v_mfma_f32_16x16x32_bf16 v[44:47], v[28:31], v[152:155], v[44:47]
v_perm_b32 v24, v56, v56, v16
v_perm_b32 v25, v56, v56, v17
v_perm_b32 v26, v56, v56, v18
v_perm_b32 v27, v56, v56, v19
v_perm_b32 v28, v56, v56, v20
v_perm_b32 v29, v56, v56, v21
v_perm_b32 v30, v56, v56, v22
v_perm_b32 v31, v56, v56, v23
v_mfma_f32_16x16x32_bf16 v[40:43], v[32:35], v[156:159], v[40:43]
v_mfma_f32_16x16x32_bf16 v[44:47], v[36:39], v[156:159], v[44:47]
v_perm_b32 v32, v57, v57, v16
v_perm_b32 v33, v57, v57, v17
v_perm_b32 v34, v57, v57, v18
v_perm_b32 v35, v57, v57, v19
v_perm_b32 v36, v57, v57, v20
v_perm_b32 v37, v57, v57, v21
v_perm_b32 v38, v57, v57, v22
v_perm_b32 v39, v57, v57, v23
v_mfma_f32_16x16x32_bf16 v[40:43], v[24:27], v[160:163], v[40:43]
v_mfma_f32_16x16x32_bf16 v[44:47], v[28:31], v[160:163], v[44:47]
v_perm_b32 v24, v58, v58, v16
v_perm_b32 v25, v58, v58, v17
v_perm_b32 v26, v58, v58, v18
v_perm_b32 v27, v58, v58, v19
v_perm_b32 v28, v58, v58, v20
v_perm_b32 v29, v58, v58, v21
v_perm_b32 v30, v58, v58, v22
v_perm_b32 v31, v58, v58, v23
v_mfma_f32_16x16x32_bf16 v[40:43], v[32:35], v[164:167], v[40:43]
v_mfma_f32_16x16x32_bf16 v[44:47], v[36:39], v[164:167], v[44:47]
v_perm_b32 v32, v59, v59, v16
v_perm_b32 v33, v59, v59, v17
v_perm_b32 v34, v59, v59, v18
v_perm_b32 v35, v59, v59, v19
v_perm_b32 v36, v59, v59, v20
v_perm_b32 v37, v59, v59, v21
v_perm_b32 v38, v59, v59, v22
v_perm_b32 v39, v59, v59, v23
v_mfma_f32_16x16x32_bf16 v[40:43], v[24:27], v[168:171], v[40:43]
v_mfma_f32_16x16x32_bf16 v[44:47], v[28:31], v[168:171], v[44:47]
v_perm_b32 v24, v60, v60, v16
v_perm_b32 v25, v60, v60, v17
v_perm_b32 v26, v60, v60, v18
v_perm_b32 v27, v60, v60, v19
v_perm_b32 v28, v60, v60, v20
v_perm_b32 v29, v60, v60, v21
v_perm_b32 v30, v60, v60, v22
v_perm_b32 v31, v60, v60, v23
v_mfma_f32_16x16x32_bf16 v[40:43], v[32:35], v[172:175], v[40:43]
v_mfma_f32_16x16x32_bf16 v[44:47], v[36:39], v[172:175], v[44:47]
v_perm_b32 v32, v61, v61, v16
v_perm_b32 v33, v61, v61, v17
v_perm_b32 v34, v61, v61, v18
v_perm_b32 v35, v61, v61, v19
v_perm_b32 v36, v61, v61, v20
v_perm_b32 v37, v61, v61, v21
v_perm_b32 v38, v61, v61, v22
v_perm_b32 v39, v61, v61, v23
v_mfma_f32_16x16x32_bf16 v[40:43], v[24:27], v[176:179], v[40:43]
v_mfma_f32_16x16x32_bf16 v[44:47], v[28:31], v[176:179], v[44:47]
v_perm_b32 v24, v62, v62, v16
v_perm_b32 v25, v62, v62, v17
v_perm_b32 v26, v62, v62, v18
v_perm_b32 v27, v62, v62, v19
v_perm_b32 v28, v62, v62, v20
v_perm_b32 v29, v62, v62, v21
v_perm_b32 v30, v62, v62, v22
v_perm_b32 v31, v62, v62, v23
v_mfma_f32_16x16x32_bf16 v[40:43], v[32:35], v[180:183], v[40:43]
v_mfma_f32_16x16x32_bf16 v[44:47], v[36:39], v[180:183], v[44:47]
v_perm_b32 v32, v63, v63, v16
v_perm_b32 v33, v63, v63, v17
v_perm_b32 v34, v63, v63, v18
v_perm_b32 v35, v63, v63, v19
v_perm_b32 v36, v63, v63, v20
v_perm_b32 v37, v63, v63, v21
v_perm_b32 v38, v63, v63, v22
v_perm_b32 v39, v63, v63, v23
v_mfma_f32_16x16x32_bf16 v[40:43], v[24:27], v[184:187], v[40:43]
v_mfma_f32_16x16x32_bf16 v[44:47], v[28:31], v[184:187], v[44:47]
v_perm_b32 v24, v64, v64, v16
v_perm_b32 v25, v64, v64, v17
v_perm_b32 v26, v64, v64, v18
v_perm_b32 v27, v64, v64, v19
v_perm_b32 v28, v64, v64, v20
v_perm_b32 v29, v64, v64, v21
v_perm_b32 v30, v64, v64, v22
v_perm_b32 v31, v64, v64, v23
v_mfma_f32_16x16x32_bf16 v[40:43], v[32:35], v[188:191], v[40:43]
v_mfma_f32_16x16x32_bf16 v[44:47], v[36:39], v[188:191], v[44:47]
v_perm_b32 v32, v65, v65, v16
v_perm_b32 v33, v65, v65, v17
v_perm_b32 v34, v65, v65, v18
v_perm_b32 v35, v65, v65, v19
v_perm_b32 v36, v65, v65, v20
v_perm_b32 v37, v65, v65, v21
v_perm_b32 v38, v65, v65, v22
v_perm_b32 v39, v65, v65, v23
v_mfma_f32_16x16x32_bf16 v[40:43], v[24:27], v[192:195], v[40:43]
v_mfma_f32_16x16x32_bf16 v[44:47], v[28:31], v[192:195], v[44:47]
v_perm_b32 v24, v66, v66, v16
v_perm_b32 v25, v66, v66, v17
v_perm_b32 v26, v66, v66, v18
v_perm_b32 v27, v66, v66, v19
v_perm_b32 v28, v66, v66, v20
v_perm_b32 v29, v66, v66, v21
v_perm_b32 v30, v66, v66, v22
v_perm_b32 v31, v66, v66, v23
v_mfma_f32_16x16x32_bf16 v[40:43], v[32:35], v[196:199], v[40:43]
v_mfma_f32_16x16x32_bf16 v[44:47], v[36:39], v[196:199], v[44:47]
v_perm_b32 v32, v67, v67, v16
v_perm_b32 v33, v67, v67, v17
v_perm_b32 v34, v67, v67, v18
v_perm_b32 v35, v67, v67, v19
v_perm_b32 v36, v67, v67, v20
v_perm_b32 v37, v67, v67, v21
v_perm_b32 v38, v67, v67, v22
v_perm_b32 v39, v67, v67, v23
v_mfma_f32_16x16x32_bf16 v[40:43], v[24:27], v[200:203], v[40:43]
v_mfma_f32_16x16x32_bf16 v[44:47], v[28:31], v[200:203], v[44:47]
s_waitcnt lgkmcnt(15)
v_perm_b32 v24, v68, v68, v16
v_perm_b32 v25, v68, v68, v17
v_perm_b32 v26, v68, v68, v18
v_perm_b32 v27, v68, v68, v19
v_perm_b32 v28, v68, v68, v20
v_perm_b32 v29, v68, v68, v21
v_perm_b32 v30, v68, v68, v22
v_perm_b32 v31, v68, v68, v23
v_mfma_f32_16x16x32_bf16 v[40:43], v[32:35], v[204:207], v[40:43]
v_mfma_f32_16x16x32_bf16 v[44:47], v[36:39], v[204:207], v[44:47]
s_waitcnt lgkmcnt(14)
v_perm_b32 v32, v69, v69, v16
v_perm_b32 v33, v69, v69, v17
v_perm_b32 v34, v69, v69, v18
v_perm_b32 v35, v69, v69, v19
v_perm_b32 v36, v69, v69, v20
v_perm_b32 v37, v69, v69, v21
v_perm_b32 v38, v69, v69, v22
v_perm_b32 v39, v69, v69, v23
v_mfma_f32_16x16x32_bf16 v[40:43], v[24:27], v[208:211], v[40:43]
v_mfma_f32_16x16x32_bf16 v[44:47], v[28:31], v[208:211], v[44:47]
s_waitcnt lgkmcnt(13)
v_perm_b32 v24, v70, v70, v16
v_perm_b32 v25, v70, v70, v17
v_perm_b32 v26, v70, v70, v18
v_perm_b32 v27, v70, v70, v19
v_perm_b32 v28, v70, v70, v20
v_perm_b32 v29, v70, v70, v21
v_perm_b32 v30, v70, v70, v22
v_perm_b32 v31, v70, v70, v23
v_mfma_f32_16x16x32_bf16 v[40:43], v[32:35], v[212:215], v[40:43]
v_mfma_f32_16x16x32_bf16 v[44:47], v[36:39], v[212:215], v[44:47]
s_waitcnt lgkmcnt(12)
v_perm_b32 v32, v71, v71, v16
v_perm_b32 v33, v71, v71, v17
v_perm_b32 v34, v71, v71, v18
v_perm_b32 v35, v71, v71, v19
v_perm_b32 v36, v71, v71, v20
v_perm_b32 v37, v71, v71, v21
v_perm_b32 v38, v71, v71, v22
v_perm_b32 v39, v71, v71, v23
v_mfma_f32_16x16x32_bf16 v[40:43], v[24:27], v[216:219], v[40:43]
v_mfma_f32_16x16x32_bf16 v[44:47], v[28:31], v[216:219], v[44:47]
s_waitcnt lgkmcnt(11)
v_perm_b32 v24, v72, v72, v16
v_perm_b32 v25, v72, v72, v17
v_perm_b32 v26, v72, v72, v18
v_perm_b32 v27, v72, v72, v19
v_perm_b32 v28, v72, v72, v20
v_perm_b32 v29, v72, v72, v21
v_perm_b32 v30, v72, v72, v22
v_perm_b32 v31, v72, v72, v23
v_mfma_f32_16x16x32_bf16 v[40:43], v[32:35], v[220:223], v[40:43]
v_mfma_f32_16x16x32_bf16 v[44:47], v[36:39], v[220:223], v[44:47]
s_waitcnt lgkmcnt(10)
v_perm_b32 v32, v73, v73, v16
v_perm_b32 v33, v73, v73, v17
v_perm_b32 v34, v73, v73, v18
v_perm_b32 v35, v73, v73, v19
v_perm_b32 v36, v73, v73, v20
v_perm_b32 v37, v73, v73, v21
v_perm_b32 v38, v73, v73, v22
v_perm_b32 v39, v73, v73, v23
v_mfma_f32_16x16x32_bf16 v[40:43], v[24:27], v[224:227], v[40:43]
v_mfma_f32_16x16x32_bf16 v[44:47], v[28:31], v[224:227], v[44:47]
s_waitcnt lgkmcnt(9)
v_perm_b32 v24, v74, v74, v16
v_perm_b32 v25, v74, v74, v17
v_perm_b32 v26, v74, v74, v18
v_perm_b32 v27, v74, v74, v19
v_perm_b32 v28, v74, v74, v20
v_perm_b32 v29, v74, v74, v21
v_perm_b32 v30, v74, v74, v22
v_perm_b32 v31, v74, v74, v23
v_mfma_f32_16x16x32_bf16 v[40:43], v[32:35], v[228:231], v[40:43]
v_mfma_f32_16x16x32_bf16 v[44:47], v[36:39], v[228:231], v[44:47]
s_waitcnt lgkmcnt(8)
v_perm_b32 v32, v75, v75, v16
v_perm_b32 v33, v75, v75, v17
v_perm_b32 v34, v75, v75, v18
v_perm_b32 v35, v75, v75, v19
v_perm_b32 v36, v75, v75, v20
v_perm_b32 v37, v75, v75, v21
v_perm_b32 v38, v75, v75, v22
v_perm_b32 v39, v75, v75, v23
v_mfma_f32_16x16x32_bf16 v[40:43], v[24:27], v[232:235], v[40:43]
v_mfma_f32_16x16x32_bf16 v[44:47], v[28:31], v[232:235], v[44:47]
s_waitcnt lgkmcnt(7)
v_perm_b32 v24, v76, v76, v16
v_perm_b32 v25, v76, v76, v17
v_perm_b32 v26, v76, v76, v18
v_perm_b32 v27, v76, v76, v19
v_perm_b32 v28, v76, v76, v20
v_perm_b32 v29, v76, v76, v21
v_perm_b32 v30, v76, v76, v22
v_perm_b32 v31, v76, v76, v23
v_mfma_f32_16x16x32_bf16 v[40:43], v[32:35], v[236:239], v[40:43]
v_mfma_f32_16x16x32_bf16 v[44:47], v[36:39], v[236:239], v[44:47]
s_waitcnt lgkmcnt(6)
v_perm_b32 v32, v77, v77, v16
v_perm_b32 v33, v77, v77, v17
v_perm_b32 v34, v77, v77, v18
v_perm_b32 v35, v77, v77, v19
v_perm_b32 v36, v77, v77, v20
v_perm_b32 v37, v77, v77, v21
v_perm_b32 v38, v77, v77, v22
v_perm_b32 v39, v77, v77, v23
v_mfma_f32_16x16x32_bf16 v[40:43], v[24:27], v[240:243], v[40:43]
v_mfma_f32_16x16x32_bf16 v[44:47], v[28:31], v[240:243], v[44:47]
s_waitcnt lgkmcnt(5)
v_perm_b32 v24, v78, v78, v16
v_perm_b32 v25, v78, v78, v17
v_perm_b32 v26, v78, v78, v18
v_perm_b32 v27, v78, v78, v19
v_perm_b32 v28, v78, v78, v20
v_perm_b32 v29, v78, v78, v21
v_perm_b32 v30, v78, v78, v22
v_perm_b32 v31, v78, v78, v23
v_mfma_f32_16x16x32_bf16 v[40:43], v[32:35], v[244:247], v[40:43]
v_mfma_f32_16x16x32_bf16 v[44:47], v[36:39], v[244:247], v[44:47]
s_waitcnt lgkmcnt(4)
v_perm_b32 v32, v79, v79, v16
v_perm_b32 v33, v79, v79, v17
v_perm_b32 v34, v79, v79, v18
v_perm_b32 v35, v79, v79, v19
v_perm_b32 v36, v79, v79, v20
v_perm_b32 v37, v79, v79, v21
v_perm_b32 v38, v79, v79, v22
v_perm_b32 v39, v79, v79, v23
v_mfma_f32_16x16x32_bf16 v[40:43], v[24:27], v[248:251], v[40:43]
v_mfma_f32_16x16x32_bf16 v[44:47], v[28:31], v[248:251], v[44:47]
s_waitcnt lgkmcnt(3)
v_perm_b32 v24, v80, v80, v16
v_perm_b32 v25, v80, v80, v17
v_perm_b32 v26, v80, v80, v18
v_perm_b32 v27, v80, v80, v19
v_perm_b32 v28, v80, v80, v20
v_perm_b32 v29, v80, v80, v21
v_perm_b32 v30, v80, v80, v22
v_perm_b32 v31, v80, v80, v23
v_mfma_f32_16x16x32_bf16 v[40:43], v[32:35], v[252:255], v[40:43]
v_mfma_f32_16x16x32_bf16 v[44:47], v[36:39], v[252:255], v[44:47]
s_waitcnt lgkmcnt(2)
v_perm_b32 v32, v81, v81, v16
v_perm_b32 v33, v81, v81, v17
v_perm_b32 v34, v81, v81, v18
v_perm_b32 v35, v81, v81, v19
v_perm_b32 v36, v81, v81, v20
v_perm_b32 v37, v81, v81, v21
v_perm_b32 v38, v81, v81, v22
v_perm_b32 v39, v81, v81, v23
v_mfma_f32_16x16x32_bf16 v[40:43], v[24:27], v[84:87], v[40:43]
v_mfma_f32_16x16x32_bf16 v[44:47], v[28:31], v[84:87], v[44:47]
s_waitcnt lgkmcnt(1)
v_perm_b32 v24, v82, v82, v16
v_perm_b32 v25, v82, v82, v17
v_perm_b32 v26, v82, v82, v18
v_perm_b32 v27, v82, v82, v19
v_perm_b32 v28, v82, v82, v20
v_perm_b32 v29, v82, v82, v21
v_perm_b32 v30, v82, v82, v22
v_perm_b32 v31, v82, v82, v23
v_mfma_f32_16x16x32_bf16 v[40:43], v[32:35], v[88:91], v[40:43]
v_mfma_f32_16x16x32_bf16 v[44:47], v[36:39], v[88:91], v[44:47]
s_waitcnt lgkmcnt(0)
v_perm_b32 v32, v83, v83, v16
v_perm_b32 v33, v83, v83, v17
v_perm_b32 v34, v83, v83, v18
v_perm_b32 v35, v83, v83, v19
v_perm_b32 v36, v83, v83, v20
v_perm_b32 v37, v83, v83, v21
v_perm_b32 v38, v83, v83, v22
v_perm_b32 v39, v83, v83, v23
v_mfma_f32_16x16x32_bf16 v[40:43], v[24:27], v[92:95], v[40:43]
v_mfma_f32_16x16x32_bf16 v[44:47], v[28:31], v[92:95], v[44:47]
v_mfma_f32_16x16x32_bf16 v[40:43], v[32:35], v[96:99], v[40:43]
v_mfma_f32_16x16x32_bf16 v[44:47], v[36:39], v[96:99], v[44:47]
s_nop 6
v_mov_b32 v120, v40
v_add_f32_dpp v120, v44, v120 row_ror:8 row_mask:0xf bank_mask:0xf
v_mov_b32 v121, v41
v_add_f32_dpp v121, v45, v121 row_ror:8 row_mask:0xf bank_mask:0xf
v_mov_b32 v122, v42
v_add_f32_dpp v122, v46, v122 row_ror:8 row_mask:0xf bank_mask:0xf
v_mov_b32 v123, v43
v_add_f32_dpp v123, v47, v123 row_ror:8 row_mask:0xf bank_mask:0xf
s_cmp_lg_u32 s79, 0
s_cbranch_scc1 L_gu_done
s_add_u32 s66, s66, 8
s_cmp_lt_u32 s66, 144
s_cselect_b32 s44, s28, s30
s_cselect_b32 s45, s29, s31
s_cselect_b32 s58, 0, 144
s_and_b32 s45, s45, 0xffff
s_mov_b32 s46, 5308416
s_mov_b32 s47, 0x20000
s_sub_u32 s58, s66, s58
s_and_b32 s59, s58, 1
s_lshr_b32 s58, s58, 1
s_lshl_b32 s69, s58, 7
s_mul_i32 s58, s59, 2654208
s_add_u32 s69, s69, s58
s_mul_i32 s61, s59, 576
buffer_load_dwordx4 v[128:131], v3, s[44:47], s69 offen nt
s_add_u32 s69, s69, 73728
buffer_load_dwordx4 v[132:135], v3, s[44:47], s69 offen nt
s_add_u32 s69, s69, 73728
buffer_load_dwordx4 v[136:139], v3, s[44:47], s69 offen nt
s_add_u32 s69, s69, 73728
buffer_load_dwordx4 v[140:143], v3, s[44:47], s69 offen nt
s_add_u32 s69, s69, 73728
buffer_load_dwordx4 v[144:147], v3, s[44:47], s69 offen nt
s_add_u32 s69, s69, 73728
buffer_load_dwordx4 v[148:151], v3, s[44:47], s69 offen nt
s_add_u32 s69, s69, 73728
buffer_load_dwordx4 v[152:155], v3, s[44:47], s69 offen nt
s_add_u32 s69, s69, 73728
buffer_load_dwordx4 v[156:159], v3, s[44:47], s69 offen nt
s_add_u32 s69, s69, 73728
buffer_load_dwordx4 v[160:163], v3, s[44:47], s69 offen nt
s_add_u32 s69, s69, 73728
buffer_load_dwordx4 v[164:167], v3, s[44:47], s69 offen nt
s_add_u32 s69, s69, 73728
buffer_load_dwordx4 v[168:171], v3, s[44:47], s69 offen nt
s_add_u32 s69, s69, 73728
buffer_load_dwordx4 v[172:175], v3, s[44:47], s69 offen nt
s_add_u32 s69, s69, 73728
buffer_load_dwordx4 v[176:179], v3, s[44:47], s69 offen nt
s_add_u32 s69, s69, 73728
buffer_load_dwordx4 v[180:183], v3, s[44:47], s69 offen nt
s_add_u32 s69, s69, 73728
buffer_load_dwordx4 v[184:187], v3, s[44:47], s69 offen nt
s_add_u32 s69, s69, 73728
buffer_load_dwordx4 v[188:191], v3, s[44:47], s69 offen nt
s_add_u32 s69, s69, 73728
buffer_load_dwordx4 v[192:195], v3, s[44:47], s69 offen nt
s_add_u32 s69, s69, 73728
buffer_load_dwordx4 v[196:199], v3, s[44:47], s69 offen nt
s_add_u32 s69, s69, 73728
buffer_load_dwordx4 v[200:203], v3, s[44:47], s69 offen nt
s_add_u32 s69, s69, 73728
buffer_load_dwordx4 v[204:207], v3, s[44:47], s69 offen nt
s_add_u32 s69, s69, 73728
buffer_load_dwordx4 v[208:211], v3, s[44:47], s69 offen nt
s_add_u32 s69, s69, 73728
buffer_load_dwordx4 v[212:215], v3, s[44:47], s69 offen nt
s_add_u32 s69, s69, 73728
buffer_load_dwordx4 v[216:219], v3, s[44:47], s69 offen nt
s_add_u32 s69, s69, 73728
buffer_load_dwordx4 v[220:223], v3, s[44:47], s69 offen nt
s_add_u32 s69, s69, 73728
buffer_load_dwordx4 v[224:227], v3, s[44:47], s69 offen nt
s_add_u32 s69, s69, 73728
buffer_load_dwordx4 v[228:231], v3, s[44:47], s69 offen nt
s_add_u32 s69, s69, 73728
buffer_load_dwordx4 v[232:235], v3, s[44:47], s69 offen nt
s_add_u32 s69, s69, 73728
buffer_load_dwordx4 v[236:239], v3, s[44:47], s69 offen nt
s_add_u32 s69, s69, 73728
buffer_load_dwordx4 v[240:243], v3, s[44:47], s69 offen nt
s_add_u32 s69, s69, 73728
buffer_load_dwordx4 v[244:247], v3, s[44:47], s69 offen nt
s_add_u32 s69, s69, 73728
buffer_load_dwordx4 v[248:251], v3, s[44:47], s69 offen nt
s_add_u32 s69, s69, 73728
buffer_load_dwordx4 v[252:255], v3, s[44:47], s69 offen nt
s_add_u32 s69, s69, 73728
buffer_load_dwordx4 v[84:87], v3, s[44:47], s69 offen nt
s_add_u32 s69, s69, 73728
buffer_load_dwordx4 v[88:91], v3, s[44:47], s69 offen nt
s_add_u32 s69, s69, 73728
buffer_load_dwordx4 v[92:95], v3, s[44:47], s69 offen nt
s_add_u32 s69, s69, 73728
buffer_load_dwordx4 v[96:99], v3, s[44:47], s69 offen nt
v_add_u32 v15, s61, v14
s_sub_u32 s66, s66, 8
s_waitcnt vmcnt(0)
ds_read_b32 v48, v15 offset:0
ds_read_b32 v49, v15 offset:16
ds_read_b32 v50, v15 offset:32
ds_read_b32 v51, v15 offset:48
ds_read_b32 v52, v15 offset:64
ds_read_b32 v53, v15 offset:80
ds_read_b32 v54, v15 offset:96
ds_read_b32 v55, v15 offset:112
ds_read_b32 v56, v15 offset:128
ds_read_b32 v57, v15 offset:144
ds_read_b32 v58, v15 offset:160
ds_read_b32 v59, v15 offset:176
ds_read_b32 v60, v15 offset:192
ds_read_b32 v61, v15 offset:208
ds_read_b32 v62, v15 offset:224
ds_read_b32 v63, v15 offset:240
ds_read_b32 v64, v15 offset:256
ds_read_b32 v65, v15 offset:272
ds_read_b32 v66, v15 offset:288
ds_read_b32 v67, v15 offset:304
ds_read_b32 v68, v15 offset:320
ds_read_b32 v69, v15 offset:336
ds_read_b32 v70, v15 offset:352
ds_read_b32 v71, v15 offset:368
ds_read_b32 v72, v15 offset:384
ds_read_b32 v73, v15 offset:400
ds_read_b32 v74, v15 offset:416
ds_read_b32 v75, v15 offset:432
ds_read_b32 v76, v15 offset:448
ds_read_b32 v77, v15 offset:464
ds_read_b32 v78, v15 offset:480
ds_read_b32 v79, v15 offset:496
ds_read_b32 v80, v15 offset:512
ds_read_b32 v81, v15 offset:528
ds_read_b32 v82, v15 offset:544
ds_read_b32 v83, v15 offset:560
s_waitcnt lgkmcnt(15)
v_perm_b32 v24, v48, v48, v16
v_perm_b32 v25, v48, v48, v17
v_perm_b32 v26, v48, v48, v18
v_perm_b32 v27, v48, v48, v19
v_perm_b32 v28, v48, v48, v20
v_perm_b32 v29, v48, v48, v21
v_perm_b32 v30, v48, v48, v22
v_perm_b32 v31, v48, v48, v23
s_waitcnt lgkmcnt(15)
v_perm_b32 v32, v49, v49, v16
v_perm_b32 v33, v49, v49, v17
v_perm_b32 v34, v49, v49, v18
v_perm_b32 v35, v49, v49, v19
v_perm_b32 v36, v49, v49, v20
v_perm_b32 v37, v49, v49, v21
v_perm_b32 v38, v49, v49, v22
v_perm_b32 v39, v49, v49, v23
v_mfma_f32_16x16x32_bf16 v[40:43], v[24:27], v[128:131], 0
v_mfma_f32_16x16x32_bf16 v[44:47], v[28:31], v[128:131], 0
v_perm_b32 v24, v50, v50, v16
v_perm_b32 v25, v50, v50, v17
v_perm_b32 v26, v50, v50, v18
v_perm_b32 v27, v50, v50, v19
v_perm_b32 v28, v50, v50, v20
v_perm_b32 v29, v50, v50, v21
v_perm_b32 v30, v50, v50, v22
v_perm_b32 v31, v50, v50, v23
v_mfma_f32_16x16x32_bf16 v[40:43], v[32:35], v[132:135], v[40:43]
v_mfma_f32_16x16x32_bf16 v[44:47], v[36:39], v[132:135], v[44:47]
v_perm_b32 v32, v51, v51, v16
v_perm_b32 v33, v51, v51, v17
v_perm_b32 v34, v51, v51, v18
v_perm_b32 v35, v51, v51, v19
v_perm_b32 v36, v51, v51, v20
v_perm_b32 v37, v51, v51, v21
v_perm_b32 v38, v51, v51, v22
v_perm_b32 v39, v51, v51, v23
v_mfma_f32_16x16x32_bf16 v[40:43], v[24:27], v[136:139], v[40:43]
v_mfma_f32_16x16x32_bf16 v[44:47], v[28:31], v[136:139], v[44:47]
v_perm_b32 v24, v52, v52, v16
v_perm_b32 v25, v52, v52, v17
v_perm_b32 v26, v52, v52, v18
v_perm_b32 v27, v52, v52, v19
v_perm_b32 v28, v52, v52, v20
v_perm_b32 v29, v52, v52, v21
v_perm_b32 v30, v52, v52, v22
v_perm_b32 v31, v52, v52, v23
v_mfma_f32_16x16x32_bf16 v[40:43], v[32:35], v[140:143], v[40:43]
v_mfma_f32_16x16x32_bf16 v[44:47], v[36:39], v[140:143], v[44:47]
v_perm_b32 v32, v53, v53, v16
v_perm_b32 v33, v53, v53, v17
v_perm_b32 v34, v53, v53, v18
v_perm_b32 v35, v53, v53, v19
v_perm_b32 v36, v53, v53, v20
v_perm_b32 v37, v53, v53, v21
v_perm_b32 v38, v53, v53, v22
v_perm_b32 v39, v53, v53, v23
v_mfma_f32_16x16x32_bf16 v[40:43], v[24:27], v[144:147], v[40:43]
v_mfma_f32_16x16x32_bf16 v[44:47], v[28:31], v[144:147], v[44:47]
v_perm_b32 v24, v54, v54, v16
v_perm_b32 v25, v54, v54, v17
v_perm_b32 v26, v54, v54, v18
v_perm_b32 v27, v54, v54, v19
v_perm_b32 v28, v54, v54, v20
v_perm_b32 v29, v54, v54, v21
v_perm_b32 v30, v54, v54, v22
v_perm_b32 v31, v54, v54, v23
v_mfma_f32_16x16x32_bf16 v[40:43], v[32:35], v[148:151], v[40:43]
v_mfma_f32_16x16x32_bf16 v[44:47], v[36:39], v[148:151], v[44:47]
v_perm_b32 v32, v55, v55, v16
v_perm_b32 v33, v55, v55, v17
v_perm_b32 v34, v55, v55, v18
v_perm_b32 v35, v55, v55, v19
v_perm_b32 v36, v55, v55, v20
v_perm_b32 v37, v55, v55, v21
v_perm_b32 v38, v55, v55, v22
v_perm_b32 v39, v55, v55, v23
v_mfma_f32_16x16x32_bf16 v[40:43], v[24:27], v[152:155], v[40:43]
v_mfma_f32_16x16x32_bf16 v[44:47], v[28:31], v[152:155], v[44:47]
v_perm_b32 v24, v56, v56, v16
v_perm_b32 v25, v56, v56, v17
v_perm_b32 v26, v56, v56, v18
v_perm_b32 v27, v56, v56, v19
v_perm_b32 v28, v56, v56, v20
v_perm_b32 v29, v56, v56, v21
v_perm_b32 v30, v56, v56, v22
v_perm_b32 v31, v56, v56, v23
v_mfma_f32_16x16x32_bf16 v[40:43], v[32:35], v[156:159], v[40:43]
v_mfma_f32_16x16x32_bf16 v[44:47], v[36:39], v[156:159], v[44:47]
v_perm_b32 v32, v57, v57, v16
v_perm_b32 v33, v57, v57, v17
v_perm_b32 v34, v57, v57, v18
v_perm_b32 v35, v57, v57, v19
v_perm_b32 v36, v57, v57, v20
v_perm_b32 v37, v57, v57, v21
v_perm_b32 v38, v57, v57, v22
v_perm_b32 v39, v57, v57, v23
v_mfma_f32_16x16x32_bf16 v[40:43], v[24:27], v[160:163], v[40:43]
v_mfma_f32_16x16x32_bf16 v[44:47], v[28:31], v[160:163], v[44:47]
v_perm_b32 v24, v58, v58, v16
v_perm_b32 v25, v58, v58, v17
v_perm_b32 v26, v58, v58, v18
v_perm_b32 v27, v58, v58, v19
v_perm_b32 v28, v58, v58, v20
v_perm_b32 v29, v58, v58, v21
v_perm_b32 v30, v58, v58, v22
v_perm_b32 v31, v58, v58, v23
v_mfma_f32_16x16x32_bf16 v[40:43], v[32:35], v[164:167], v[40:43]
v_mfma_f32_16x16x32_bf16 v[44:47], v[36:39], v[164:167], v[44:47]
v_perm_b32 v32, v59, v59, v16
v_perm_b32 v33, v59, v59, v17
v_perm_b32 v34, v59, v59, v18
v_perm_b32 v35, v59, v59, v19
v_perm_b32 v36, v59, v59, v20
v_perm_b32 v37, v59, v59, v21
v_perm_b32 v38, v59, v59, v22
v_perm_b32 v39, v59, v59, v23
v_mfma_f32_16x16x32_bf16 v[40:43], v[24:27], v[168:171], v[40:43]
v_mfma_f32_16x16x32_bf16 v[44:47], v[28:31], v[168:171], v[44:47]
v_perm_b32 v24, v60, v60, v16
v_perm_b32 v25, v60, v60, v17
v_perm_b32 v26, v60, v60, v18
v_perm_b32 v27, v60, v60, v19
v_perm_b32 v28, v60, v60, v20
v_perm_b32 v29, v60, v60, v21
v_perm_b32 v30, v60, v60, v22
v_perm_b32 v31, v60, v60, v23
v_mfma_f32_16x16x32_bf16 v[40:43], v[32:35], v[172:175], v[40:43]
v_mfma_f32_16x16x32_bf16 v[44:47], v[36:39], v[172:175], v[44:47]
v_perm_b32 v32, v61, v61, v16
v_perm_b32 v33, v61, v61, v17
v_perm_b32 v34, v61, v61, v18
v_perm_b32 v35, v61, v61, v19
v_perm_b32 v36, v61, v61, v20
v_perm_b32 v37, v61, v61, v21
v_perm_b32 v38, v61, v61, v22
v_perm_b32 v39, v61, v61, v23
v_mfma_f32_16x16x32_bf16 v[40:43], v[24:27], v[176:179], v[40:43]
v_mfma_f32_16x16x32_bf16 v[44:47], v[28:31], v[176:179], v[44:47]
v_perm_b32 v24, v62, v62, v16
v_perm_b32 v25, v62, v62, v17
v_perm_b32 v26, v62, v62, v18
v_perm_b32 v27, v62, v62, v19
v_perm_b32 v28, v62, v62, v20
v_perm_b32 v29, v62, v62, v21
v_perm_b32 v30, v62, v62, v22
v_perm_b32 v31, v62, v62, v23
v_mfma_f32_16x16x32_bf16 v[40:43], v[32:35], v[180:183], v[40:43]
v_mfma_f32_16x16x32_bf16 v[44:47], v[36:39], v[180:183], v[44:47]
v_perm_b32 v32, v63, v63, v16
v_perm_b32 v33, v63, v63, v17
v_perm_b32 v34, v63, v63, v18
v_perm_b32 v35, v63, v63, v19
v_perm_b32 v36, v63, v63, v20
v_perm_b32 v37, v63, v63, v21
v_perm_b32 v38, v63, v63, v22
v_perm_b32 v39, v63, v63, v23
v_mfma_f32_16x16x32_bf16 v[40:43], v[24:27], v[184:187], v[40:43]
v_mfma_f32_16x16x32_bf16 v[44:47], v[28:31], v[184:187], v[44:47]
v_perm_b32 v24, v64, v64, v16
v_perm_b32 v25, v64, v64, v17
v_perm_b32 v26, v64, v64, v18
v_perm_b32 v27, v64, v64, v19
v_perm_b32 v28, v64, v64, v20
v_perm_b32 v29, v64, v64, v21
v_perm_b32 v30, v64, v64, v22
v_perm_b32 v31, v64, v64, v23
v_mfma_f32_16x16x32_bf16 v[40:43], v[32:35], v[188:191], v[40:43]
v_mfma_f32_16x16x32_bf16 v[44:47], v[36:39], v[188:191], v[44:47]
v_perm_b32 v32, v65, v65, v16
v_perm_b32 v33, v65, v65, v17
v_perm_b32 v34, v65, v65, v18
v_perm_b32 v35, v65, v65, v19
v_perm_b32 v36, v65, v65, v20
v_perm_b32 v37, v65, v65, v21
v_perm_b32 v38, v65, v65, v22
v_perm_b32 v39, v65, v65, v23
v_mfma_f32_16x16x32_bf16 v[40:43], v[24:27], v[192:195], v[40:43]
v_mfma_f32_16x16x32_bf16 v[44:47], v[28:31], v[192:195], v[44:47]
v_perm_b32 v24, v66, v66, v16
v_perm_b32 v25, v66, v66, v17
v_perm_b32 v26, v66, v66, v18
v_perm_b32 v27, v66, v66, v19
v_perm_b32 v28, v66, v66, v20
v_perm_b32 v29, v66, v66, v21
v_perm_b32 v30, v66, v66, v22
v_perm_b32 v31, v66, v66, v23
v_mfma_f32_16x16x32_bf16 v[40:43], v[32:35], v[196:199], v[40:43]
v_mfma_f32_16x16x32_bf16 v[44:47], v[36:39], v[196:199], v[44:47]
v_perm_b32 v32, v67, v67, v16
v_perm_b32 v33, v67, v67, v17
v_perm_b32 v34, v67, v67, v18
v_perm_b32 v35, v67, v67, v19
v_perm_b32 v36, v67, v67, v20
v_perm_b32 v37, v67, v67, v21
v_perm_b32 v38, v67, v67, v22
v_perm_b32 v39, v67, v67, v23
v_mfma_f32_16x16x32_bf16 v[40:43], v[24:27], v[200:203], v[40:43]
v_mfma_f32_16x16x32_bf16 v[44:47], v[28:31], v[200:203], v[44:47]
s_waitcnt lgkmcnt(15)
v_perm_b32 v24, v68, v68, v16
v_perm_b32 v25, v68, v68, v17
v_perm_b32 v26, v68, v68, v18
v_perm_b32 v27, v68, v68, v19
v_perm_b32 v28, v68, v68, v20
v_perm_b32 v29, v68, v68, v21
v_perm_b32 v30, v68, v68, v22
v_perm_b32 v31, v68, v68, v23
v_mfma_f32_16x16x32_bf16 v[40:43], v[32:35], v[204:207], v[40:43]
v_mfma_f32_16x16x32_bf16 v[44:47], v[36:39], v[204:207], v[44:47]
s_waitcnt lgkmcnt(14)
v_perm_b32 v32, v69, v69, v16
v_perm_b32 v33, v69, v69, v17
v_perm_b32 v34, v69, v69, v18
v_perm_b32 v35, v69, v69, v19
v_perm_b32 v36, v69, v69, v20
v_perm_b32 v37, v69, v69, v21
v_perm_b32 v38, v69, v69, v22
v_perm_b32 v39, v69, v69, v23
v_mfma_f32_16x16x32_bf16 v[40:43], v[24:27], v[208:211], v[40:43]
v_mfma_f32_16x16x32_bf16 v[44:47], v[28:31], v[208:211], v[44:47]
s_waitcnt lgkmcnt(13)
v_perm_b32 v24, v70, v70, v16
v_perm_b32 v25, v70, v70, v17
v_perm_b32 v26, v70, v70, v18
v_perm_b32 v27, v70, v70, v19
v_perm_b32 v28, v70, v70, v20
v_perm_b32 v29, v70, v70, v21
v_perm_b32 v30, v70, v70, v22
v_perm_b32 v31, v70, v70, v23
v_mfma_f32_16x16x32_bf16 v[40:43], v[32:35], v[212:215], v[40:43]
v_mfma_f32_16x16x32_bf16 v[44:47], v[36:39], v[212:215], v[44:47]
s_waitcnt lgkmcnt(12)
v_perm_b32 v32, v71, v71, v16
v_perm_b32 v33, v71, v71, v17
v_perm_b32 v34, v71, v71, v18
v_perm_b32 v35, v71, v71, v19
v_perm_b32 v36, v71, v71, v20
v_perm_b32 v37, v71, v71, v21
v_perm_b32 v38, v71, v71, v22
v_perm_b32 v39, v71, v71, v23
v_mfma_f32_16x16x32_bf16 v[40:43], v[24:27], v[216:219], v[40:43]
v_mfma_f32_16x16x32_bf16 v[44:47], v[28:31], v[216:219], v[44:47]
s_waitcnt lgkmcnt(11)
v_perm_b32 v24, v72, v72, v16
v_perm_b32 v25, v72, v72, v17
v_perm_b32 v26, v72, v72, v18
v_perm_b32 v27, v72, v72, v19
v_perm_b32 v28, v72, v72, v20
v_perm_b32 v29, v72, v72, v21
v_perm_b32 v30, v72, v72, v22
v_perm_b32 v31, v72, v72, v23
v_mfma_f32_16x16x32_bf16 v[40:43], v[32:35], v[220:223], v[40:43]
v_mfma_f32_16x16x32_bf16 v[44:47], v[36:39], v[220:223], v[44:47]
s_waitcnt lgkmcnt(10)
v_perm_b32 v32, v73, v73, v16
v_perm_b32 v33, v73, v73, v17
v_perm_b32 v34, v73, v73, v18
v_perm_b32 v35, v73, v73, v19
v_perm_b32 v36, v73, v73, v20
v_perm_b32 v37, v73, v73, v21
v_perm_b32 v38, v73, v73, v22
v_perm_b32 v39, v73, v73, v23
v_mfma_f32_16x16x32_bf16 v[40:43], v[24:27], v[224:227], v[40:43]
v_mfma_f32_16x16x32_bf16 v[44:47], v[28:31], v[224:227], v[44:47]
s_waitcnt lgkmcnt(9)
v_perm_b32 v24, v74, v74, v16
v_perm_b32 v25, v74, v74, v17
v_perm_b32 v26, v74, v74, v18
v_perm_b32 v27, v74, v74, v19
v_perm_b32 v28, v74, v74, v20
v_perm_b32 v29, v74, v74, v21
v_perm_b32 v30, v74, v74, v22
v_perm_b32 v31, v74, v74, v23
v_mfma_f32_16x16x32_bf16 v[40:43], v[32:35], v[228:231], v[40:43]
v_mfma_f32_16x16x32_bf16 v[44:47], v[36:39], v[228:231], v[44:47]
s_waitcnt lgkmcnt(8)
v_perm_b32 v32, v75, v75, v16
v_perm_b32 v33, v75, v75, v17
v_perm_b32 v34, v75, v75, v18
v_perm_b32 v35, v75, v75, v19
v_perm_b32 v36, v75, v75, v20
v_perm_b32 v37, v75, v75, v21
v_perm_b32 v38, v75, v75, v22
v_perm_b32 v39, v75, v75, v23
v_mfma_f32_16x16x32_bf16 v[40:43], v[24:27], v[232:235], v[40:43]
v_mfma_f32_16x16x32_bf16 v[44:47], v[28:31], v[232:235], v[44:47]
s_waitcnt lgkmcnt(7)
v_perm_b32 v24, v76, v76, v16
v_perm_b32 v25, v76, v76, v17
v_perm_b32 v26, v76, v76, v18
v_perm_b32 v27, v76, v76, v19
v_perm_b32 v28, v76, v76, v20
v_perm_b32 v29, v76, v76, v21
v_perm_b32 v30, v76, v76, v22
v_perm_b32 v31, v76, v76, v23
v_mfma_f32_16x16x32_bf16 v[40:43], v[32:35], v[236:239], v[40:43]
v_mfma_f32_16x16x32_bf16 v[44:47], v[36:39], v[236:239], v[44:47]
s_waitcnt lgkmcnt(6)
v_perm_b32 v32, v77, v77, v16
v_perm_b32 v33, v77, v77, v17
v_perm_b32 v34, v77, v77, v18
v_perm_b32 v35, v77, v77, v19
v_perm_b32 v36, v77, v77, v20
v_perm_b32 v37, v77, v77, v21
v_perm_b32 v38, v77, v77, v22
v_perm_b32 v39, v77, v77, v23
v_mfma_f32_16x16x32_bf16 v[40:43], v[24:27], v[240:243], v[40:43]
v_mfma_f32_16x16x32_bf16 v[44:47], v[28:31], v[240:243], v[44:47]
s_waitcnt lgkmcnt(5)
v_perm_b32 v24, v78, v78, v16
v_perm_b32 v25, v78, v78, v17
v_perm_b32 v26, v78, v78, v18
v_perm_b32 v27, v78, v78, v19
v_perm_b32 v28, v78, v78, v20
v_perm_b32 v29, v78, v78, v21
v_perm_b32 v30, v78, v78, v22
v_perm_b32 v31, v78, v78, v23
v_mfma_f32_16x16x32_bf16 v[40:43], v[32:35], v[244:247], v[40:43]
v_mfma_f32_16x16x32_bf16 v[44:47], v[36:39], v[244:247], v[44:47]
s_waitcnt lgkmcnt(4)
v_perm_b32 v32, v79, v79, v16
v_perm_b32 v33, v79, v79, v17
v_perm_b32 v34, v79, v79, v18
v_perm_b32 v35, v79, v79, v19
v_perm_b32 v36, v79, v79, v20
v_perm_b32 v37, v79, v79, v21
v_perm_b32 v38, v79, v79, v22
v_perm_b32 v39, v79, v79, v23
v_mfma_f32_16x16x32_bf16 v[40:43], v[24:27], v[248:251], v[40:43]
v_mfma_f32_16x16x32_bf16 v[44:47], v[28:31], v[248:251], v[44:47]
s_waitcnt lgkmcnt(3)
v_perm_b32 v24, v80, v80, v16
v_perm_b32 v25, v80, v80, v17
v_perm_b32 v26, v80, v80, v18
v_perm_b32 v27, v80, v80, v19
v_perm_b32 v28, v80, v80, v20
v_perm_b32 v29, v80, v80, v21
v_perm_b32 v30, v80, v80, v22
v_perm_b32 v31, v80, v80, v23
v_mfma_f32_16x16x32_bf16 v[40:43], v[32:35], v[252:255], v[40:43]
v_mfma_f32_16x16x32_bf16 v[44:47], v[36:39], v[252:255], v[44:47]
s_waitcnt lgkmcnt(2)
v_perm_b32 v32, v81, v81, v16
v_perm_b32 v33, v81, v81, v17
v_perm_b32 v34, v81, v81, v18
v_perm_b32 v35, v81, v81, v19
v_perm_b32 v36, v81, v81, v20
v_perm_b32 v37, v81, v81, v21
v_perm_b32 v38, v81, v81, v22
v_perm_b32 v39, v81, v81, v23
v_mfma_f32_16x16x32_bf16 v[40:43], v[24:27], v[84:87], v[40:43]
v_mfma_f32_16x16x32_bf16 v[44:47], v[28:31], v[84:87], v[44:47]
s_waitcnt lgkmcnt(1)
v_perm_b32 v24, v82, v82, v16
v_perm_b32 v25, v82, v82, v17
v_perm_b32 v26, v82, v82, v18
v_perm_b32 v27, v82, v82, v19
v_perm_b32 v28, v82, v82, v20
v_perm_b32 v29, v82, v82, v21
v_perm_b32 v30, v82, v82, v22
v_perm_b32 v31, v82, v82, v23
v_mfma_f32_16x16x32_bf16 v[40:43], v[32:35], v[88:91], v[40:43]
v_mfma_f32_16x16x32_bf16 v[44:47], v[36:39], v[88:91], v[44:47]
s_waitcnt lgkmcnt(0)
v_perm_b32 v32, v83, v83, v16
v_perm_b32 v33, v83, v83, v17
v_perm_b32 v34, v83, v83, v18
v_perm_b32 v35, v83, v83, v19
v_perm_b32 v36, v83, v83, v20
v_perm_b32 v37, v83, v83, v21
v_perm_b32 v38, v83, v83, v22
v_perm_b32 v39, v83, v83, v23
v_mfma_f32_16x16x32_bf16 v[40:43], v[24:27], v[92:95], v[40:43]
v_mfma_f32_16x16x32_bf16 v[44:47], v[28:31], v[92:95], v[44:47]
v_mfma_f32_16x16x32_bf16 v[40:43], v[32:35], v[96:99], v[40:43]
v_mfma_f32_16x16x32_bf16 v[44:47], v[36:39], v[96:99], v[44:47]
s_nop 6
v_mov_b32 v124, v40
v_add_f32_dpp v124, v44, v124 row_ror:8 row_mask:0xf bank_mask:0xf
v_mov_b32 v125, v41
v_add_f32_dpp v125, v45, v125 row_ror:8 row_mask:0xf bank_mask:0xf
v_mov_b32 v126, v42
v_add_f32_dpp v126, v46, v126 row_ror:8 row_mask:0xf bank_mask:0xf
v_mov_b32 v127, v43
v_add_f32_dpp v127, v47, v127 row_ror:8 row_mask:0xf bank_mask:0xf
s_nop 1
L_gu_done:
v_mul_u32_u24 v3, 1152, v1
v_add_u32 v3, v3, v2
s_cmp_eq_u32 s72, 0
s_cbranch_scc1 L_nodl_20
s_mov_b32 s44, s32
s_and_b32 s45, s33, 0xffff
s_mov_b32 s46, 5308416
s_mov_b32 s47, 0x20000
s_mul_i32 s69, s74, 294912
s_lshl_b32 s58, s75, 7
s_add_u32 s69, s69, s58
buffer_load_dwordx4 v[128:131], v3, s[44:47], s69 offen nt
s_add_u32 s69, s69, 9216
buffer_load_dwordx4 v[132:135], v3, s[44:47], s69 offen nt
s_add_u32 s69, s69, 9216
buffer_load_dwordx4 v[136:139], v3, s[44:47], s69 offen nt
s_add_u32 s69, s69, 9216
buffer_load_dwordx4 v[140:143], v3, s[44:47], s69 offen nt
s_add_u32 s69, s69, 9216
buffer_load_dwordx4 v[144:147], v3, s[44:47], s69 offen nt
s_add_u32 s69, s69, 9216
buffer_load_dwordx4 v[148:151], v3, s[44:47], s69 offen nt
s_add_u32 s69, s69, 9216
buffer_load_dwordx4 v[152:155], v3, s[44:47], s69 offen nt
s_add_u32 s69, s69, 9216
buffer_load_dwordx4 v[156:159], v3, s[44:47], s69 offen nt
s_add_u32 s69, s69, 9216
buffer_load_dwordx4 v[160:163], v3, s[44:47], s69 offen nt
s_add_u32 s69, s69, 9216
buffer_load_dwordx4 v[164:167], v3, s[44:47], s69 offen nt
s_add_u32 s69, s69, 9216
buffer_load_dwordx4 v[168:171], v3, s[44:47], s69 offen nt
s_add_u32 s69, s69, 9216
buffer_load_dwordx4 v[172:175], v3, s[44:47], s69 offen nt
s_add_u32 s69, s69, 9216
buffer_load_dwordx4 v[176:179], v3, s[44:47], s69 offen nt
s_add_u32 s69, s69, 9216
buffer_load_dwordx4 v[180:183], v3, s[44:47], s69 offen nt
s_add_u32 s69, s69, 9216
buffer_load_dwordx4 v[184:187], v3, s[44:47], s69 offen nt
s_add_u32 s69, s69, 9216
buffer_load_dwordx4 v[188:191], v3, s[44:47], s69 offen nt
s_add_u32 s69, s69, 9216
buffer_load_dwordx4 v[192:195], v3, s[44:47], s69 offen nt
s_add_u32 s69, s69, 9216
buffer_load_dwordx4 v[196:199], v3, s[44:47], s69 offen nt
s_add_u32 s69, s69, 9216
buffer_load_dwordx4 v[200:203], v3, s[44:47], s69 offen nt
s_add_u32 s69, s69, 9216
buffer_load_dwordx4 v[204:207], v3, s[44:47], s69 offen nt
s_add_u32 s69, s69, 9216
buffer_load_dwordx4 v[208:211], v3, s[44:47], s69 offen nt
s_add_u32 s69, s69, 9216
buffer_load_dwordx4 v[212:215], v3, s[44:47], s69 offen nt
s_add_u32 s69, s69, 9216
buffer_load_dwordx4 v[216:219], v3, s[44:47], s69 offen nt
s_add_u32 s69, s69, 9216
buffer_load_dwordx4 v[220:223], v3, s[44:47], s69 offen nt
s_add_u32 s69, s69, 9216
buffer_load_dwordx4 v[224:227], v3, s[44:47], s69 offen nt
s_add_u32 s69, s69, 9216
buffer_load_dwordx4 v[228:231], v3, s[44:47], s69 offen nt
s_add_u32 s69, s69, 9216
buffer_load_dwordx4 v[232:235], v3, s[44:47], s69 offen nt
s_add_u32 s69, s69, 9216
buffer_load_dwordx4 v[236:239], v3, s[44:47], s69 offen nt
s_add_u32 s69, s69, 9216
buffer_load_dwordx4 v[240:243], v3, s[44:47], s69 offen nt
s_add_u32 s69, s69, 9216
buffer_load_dwordx4 v[244:247], v3, s[44:47], s69 offen nt
s_add_u32 s69, s69, 9216
buffer_load_dwordx4 v[248:251], v3, s[44:47], s69 offen nt
s_add_u32 s69, s69, 9216
buffer_load_dwordx4 v[252:255], v3, s[44:47], s69 offen nt
L_nodl_20:
s_mov_b64 exec, 1
s_mov_b32 s62, 1000000
L_hs_21:
buffer_load_dword v9, v8, s[52:55], 0 offen offset:128 sc1
s_waitcnt vmcnt(0)
v_cmp_ne_u32 vcc, 1, v9
s_nop 3
s_cbranch_vccz L_hsd_22
s_sleep 4
s_sub_u32 s62, s62, 1
s_cmp_lg_u32 s62, 0
s_cbranch_scc1 L_hs_21
L_hsd_22:
v_mov_b32 v9, 1
s_waitcnt lgkmcnt(0)
ds_write_b32 v8, v9 offset:9028
s_mov_b64 exec, -1
s_lshl_b32 s58, s66, 9
s_add_u32 s58, s58, 0
v_min_u32 v120, -2, v120
v_min_u32 v121, -2, v121
v_min_u32 v122, -2, v122
v_min_u32 v123, -2, v123
s_mov_b64 exec, s[56:57]
buffer_store_dwordx4 v[120:123], v5, s[40:43], s58 offen sc1
s_mov_b64 exec, -1
s_cmp_lg_u32 s79, 0
s_cbranch_scc1 L_gu2_23
s_add_u32 s58, s58, 4096
v_min_u32 v124, -2, v124
v_min_u32 v125, -2, v125
v_min_u32 v126, -2, v126
v_min_u32 v127, -2, v127
s_mov_b64 exec, s[56:57]
buffer_store_dwordx4 v[124:127], v5, s[40:43], s58 offen sc1
s_mov_b64 exec, -1
s_nop 0
L_gu2_23:
s_cmp_eq_u32 s72, 0
s_cbranch_scc1 L_nodown_24
v_lshrrev_b32 v9, 4, v0
v_lshlrev_b32 v9, 10, v9
v_and_b32 v10, 15, v0
v_lshl_add_u32 v14, v10, 4, v9
s_lshl_b32 s58, s74, 12
s_add_u32 s58, s58, 0
s_add_u32 s59, s58, 73728
s_mov_b32 s62, 1000000
L_poll_25:
buffer_load_dwordx4 v[24:27], v14, s[40:43], s58 offen offset:0 sc1
buffer_load_dwordx4 v[28:31], v14, s[40:43], s59 offen offset:0 sc1
buffer_load_dwordx4 v[32:35], v14, s[40:43], s58 offen offset:256 sc1
buffer_load_dwordx4 v[36:39], v14, s[40:43], s59 offen offset:256 sc1
buffer_load_dwordx4 v[40:43], v14, s[40:43], s58 offen offset:512 sc1
buffer_load_dwordx4 v[44:47], v14, s[40:43], s59 offen offset:512 sc1
buffer_load_dwordx4 v[48:51], v14, s[40:43], s58 offen offset:768 sc1
buffer_load_dwordx4 v[52:55], v14, s[40:43], s59 offen offset:768 sc1
s_waitcnt vmcnt(0)
v_max3_u32 v9, v24, v25, v26
v_max3_u32 v9, v9, v27, v28
v_max3_u32 v9, v9, v29, v30
v_max3_u32 v9, v9, v31, v32
v_max3_u32 v9, v9, v33, v34
v_max3_u32 v9, v9, v35, v36
v_max3_u32 v9, v9, v37, v38
v_max3_u32 v9, v9, v39, v40
v_max3_u32 v9, v9, v41, v42
v_max3_u32 v9, v9, v43, v44
v_max3_u32 v9, v9, v45, v46
v_max3_u32 v9, v9, v47, v48
v_max3_u32 v9, v9, v49, v50
v_max3_u32 v9, v9, v51, v52
v_max3_u32 v9, v9, v53, v54
v_max_u32 v9, v9, v55
v_cmp_eq_u32 vcc, -1, v9
s_nop 3
s_cbranch_vccz L_polld_26
s_sleep 8
s_sub_u32 s62, s62, 1
s_cmp_lg_u32 s62, 0
s_cbranch_scc1 L_poll_25
L_polld_26:
v_add_f32 v24, v24, v40
v_add_f32 v25, v25, v41
v_add_f32 v26, v26, v42
v_add_f32 v27, v27, v43
v_add_f32 v28, v28, v44
v_add_f32 v29, v29, v45
v_add_f32 v30, v30, v46
v_add_f32 v31, v31, v47
v_add_f32 v32, v32, v48
v_add_f32 v33, v33, v49
v_add_f32 v34, v34, v50
v_add_f32 v35, v35, v51
v_add_f32 v36, v36, v52
v_add_f32 v37, v37, v53
v_add_f32 v38, v38, v54
v_add_f32 v39, v39, v55
s_mov_b32 s60, 0x3d372713
s_mov_b32 s61, 0xc0135761
v_cvt_pk_bf16_f32 v9, v24, v28
v_lshlrev_b32 v24, 16, v9
v_and_b32 v28, 0xffff0000, v9
v_mul_f32 v9, v24, v24
v_mul_f32 v9, v9, v24
v_fma_f32 v9, v9, s60, v24
v_mul_f32 v9, s61, v9
v_exp_f32 v9, v9
s_nop 0
v_add_f32 v9, 1.0, v9
v_rcp_f32 v10, v9
s_nop 0
v_mul_f32 v24, v24, v10
v_cvt_pk_bf16_f32 v24, v24, v24
v_lshlrev_b32 v24, 16, v24
v_mul_f32 v24, v24, v28
v_cvt_pk_bf16_f32 v9, v25, v29
v_lshlrev_b32 v25, 16, v9
v_and_b32 v29, 0xffff0000, v9
v_mul_f32 v9, v25, v25
v_mul_f32 v9, v9, v25
v_fma_f32 v9, v9, s60, v25
v_mul_f32 v9, s61, v9
v_exp_f32 v9, v9
s_nop 0
v_add_f32 v9, 1.0, v9
v_rcp_f32 v10, v9
s_nop 0
v_mul_f32 v25, v25, v10
v_cvt_pk_bf16_f32 v25, v25, v25
v_lshlrev_b32 v25, 16, v25
v_mul_f32 v25, v25, v29
v_cvt_pk_bf16_f32 v9, v26, v30
v_lshlrev_b32 v26, 16, v9
v_and_b32 v30, 0xffff0000, v9
v_mul_f32 v9, v26, v26
v_mul_f32 v9, v9, v26
v_fma_f32 v9, v9, s60, v26
v_mul_f32 v9, s61, v9
v_exp_f32 v9, v9
s_nop 0
v_add_f32 v9, 1.0, v9
v_rcp_f32 v10, v9
s_nop 0
v_mul_f32 v26, v26, v10
v_cvt_pk_bf16_f32 v26, v26, v26
v_lshlrev_b32 v26, 16, v26
v_mul_f32 v26, v26, v30
v_cvt_pk_bf16_f32 v9, v27, v31
v_lshlrev_b32 v27, 16, v9
v_and_b32 v31, 0xffff0000, v9
v_mul_f32 v9, v27, v27
v_mul_f32 v9, v9, v27
v_fma_f32 v9, v9, s60, v27
v_mul_f32 v9, s61, v9
v_exp_f32 v9, v9
s_nop 0
v_add_f32 v9, 1.0, v9
v_rcp_f32 v10, v9
s_nop 0
v_mul_f32 v27, v27, v10
v_cvt_pk_bf16_f32 v27, v27, v27
v_lshlrev_b32 v27, 16, v27
v_mul_f32 v27, v27, v31
v_cvt_pk_bf16_f32 v120, v24, v25
v_cvt_pk_bf16_f32 v121, v26, v27
v_cvt_pk_bf16_f32 v9, v32, v36
v_lshlrev_b32 v32, 16, v9
v_and_b32 v36, 0xffff0000, v9
v_mul_f32 v9, v32, v32
v_mul_f32 v9, v9, v32
v_fma_f32 v9, v9, s60, v32
v_mul_f32 v9, s61, v9
v_exp_f32 v9, v9
s_nop 0
v_add_f32 v9, 1.0, v9
v_rcp_f32 v10, v9
s_nop 0
v_mul_f32 v32, v32, v10
v_cvt_pk_bf16_f32 v32, v32, v32
v_lshlrev_b32 v32, 16, v32
v_mul_f32 v32, v32, v36
v_cvt_pk_bf16_f32 v9, v33, v37
v_lshlrev_b32 v33, 16, v9
v_and_b32 v37, 0xffff0000, v9
v_mul_f32 v9, v33, v33
v_mul_f32 v9, v9, v33
v_fma_f32 v9, v9, s60, v33
v_mul_f32 v9, s61, v9
v_exp_f32 v9, v9
s_nop 0
v_add_f32 v9, 1.0, v9
v_rcp_f32 v10, v9
s_nop 0
v_mul_f32 v33, v33, v10
v_cvt_pk_bf16_f32 v33, v33, v33
v_lshlrev_b32 v33, 16, v33
v_mul_f32 v33, v33, v37
v_cvt_pk_bf16_f32 v9, v34, v38
v_lshlrev_b32 v34, 16, v9
v_and_b32 v38, 0xffff0000, v9
v_mul_f32 v9, v34, v34
v_mul_f32 v9, v9, v34
v_fma_f32 v9, v9, s60, v34
v_mul_f32 v9, s61, v9
v_exp_f32 v9, v9
s_nop 0
v_add_f32 v9, 1.0, v9
v_rcp_f32 v10, v9
s_nop 0
v_mul_f32 v34, v34, v10
v_cvt_pk_bf16_f32 v34, v34, v34
v_lshlrev_b32 v34, 16, v34
v_mul_f32 v34, v34, v38
v_cvt_pk_bf16_f32 v9, v35, v39
v_lshlrev_b32 v35, 16, v9
v_and_b32 v39, 0xffff0000, v9
v_mul_f32 v9, v35, v35
v_mul_f32 v9, v9, v35
v_fma_f32 v9, v9, s60, v35
v_mul_f32 v9, s61, v9
v_exp_f32 v9, v9
s_nop 0
v_add_f32 v9, 1.0, v9
v_rcp_f32 v10, v9
s_nop 0
v_mul_f32 v35, v35, v10
v_cvt_pk_bf16_f32 v35, v35, v35
v_lshlrev_b32 v35, 16, v35
v_mul_f32 v35, v35, v39
v_cvt_pk_bf16_f32 v122, v32, v33
v_cvt_pk_bf16_f32 v123, v34, v35
v_lshlrev_b32 v9, 3, v0
ds_write_b64 v9, v[120:121] offset:2816
ds_write_b64 v9, v[122:123] offset:3328
v_lshl_add_u32 v12, v7, 9, v4
ds_read_b32 v48, v12 offset:2816
ds_read_b32 v49, v12 offset:2832
ds_read_b32 v50, v12 offset:2848
ds_read_b32 v51, v12 offset:2864
ds_read_b32 v52, v12 offset:2880
ds_read_b32 v53, v12 offset:2896
ds_read_b32 v54, v12 offset:2912
ds_read_b32 v55, v12 offset:2928
ds_read_b32 v56, v12 offset:2944
ds_read_b32 v57, v12 offset:2960
ds_read_b32 v58, v12 offset:2976
ds_read_b32 v59, v12 offset:2992
ds_read_b32 v60, v12 offset:3008
ds_read_b32 v61, v12 offset:3024
ds_read_b32 v62, v12 offset:3040
ds_read_b32 v63, v12 offset:3056
ds_read_b32 v64, v12 offset:3072
ds_read_b32 v65, v12 offset:3088
ds_read_b32 v66, v12 offset:3104
ds_read_b32 v67, v12 offset:3120
ds_read_b32 v68, v12 offset:3136
ds_read_b32 v69, v12 offset:3152
ds_read_b32 v70, v12 offset:3168
ds_read_b32 v71, v12 offset:3184
ds_read_b32 v72, v12 offset:3200
ds_read_b32 v73, v12 offset:3216
ds_read_b32 v74, v12 offset:3232
ds_read_b32 v75, v12 offset:3248
ds_read_b32 v76, v12 offset:3264
ds_read_b32 v77, v12 offset:3280
ds_read_b32 v78, v12 offset:3296
ds_read_b32 v79, v12 offset:3312
s_waitcnt lgkmcnt(15)
v_perm_b32 v24, v48, v48, v16
v_perm_b32 v25, v48, v48, v17
v_perm_b32 v26, v48, v48, v18
v_perm_b32 v27, v48, v48, v19
v_perm_b32 v28, v48, v48, v20
v_perm_b32 v29, v48, v48, v21
v_perm_b32 v30, v48, v48, v22
v_perm_b32 v31, v48, v48, v23
s_waitcnt lgkmcnt(15)
v_perm_b32 v32, v49, v49, v16
v_perm_b32 v33, v49, v49, v17
v_perm_b32 v34, v49, v49, v18
v_perm_b32 v35, v49, v49, v19
v_perm_b32 v36, v49, v49, v20
v_perm_b32 v37, v49, v49, v21
v_perm_b32 v38, v49, v49, v22
v_perm_b32 v39, v49, v49, v23
v_mfma_f32_16x16x32_bf16 v[40:43], v[24:27], v[128:131], 0
v_mfma_f32_16x16x32_bf16 v[44:47], v[28:31], v[128:131], 0
v_perm_b32 v24, v50, v50, v16
v_perm_b32 v25, v50, v50, v17
v_perm_b32 v26, v50, v50, v18
v_perm_b32 v27, v50, v50, v19
v_perm_b32 v28, v50, v50, v20
v_perm_b32 v29, v50, v50, v21
v_perm_b32 v30, v50, v50, v22
v_perm_b32 v31, v50, v50, v23
v_mfma_f32_16x16x32_bf16 v[40:43], v[32:35], v[132:135], v[40:43]
v_mfma_f32_16x16x32_bf16 v[44:47], v[36:39], v[132:135], v[44:47]
v_perm_b32 v32, v51, v51, v16
v_perm_b32 v33, v51, v51, v17
v_perm_b32 v34, v51, v51, v18
v_perm_b32 v35, v51, v51, v19
v_perm_b32 v36, v51, v51, v20
v_perm_b32 v37, v51, v51, v21
v_perm_b32 v38, v51, v51, v22
v_perm_b32 v39, v51, v51, v23
v_mfma_f32_16x16x32_bf16 v[40:43], v[24:27], v[136:139], v[40:43]
v_mfma_f32_16x16x32_bf16 v[44:47], v[28:31], v[136:139], v[44:47]
v_perm_b32 v24, v52, v52, v16
v_perm_b32 v25, v52, v52, v17
v_perm_b32 v26, v52, v52, v18
v_perm_b32 v27, v52, v52, v19
v_perm_b32 v28, v52, v52, v20
v_perm_b32 v29, v52, v52, v21
v_perm_b32 v30, v52, v52, v22
v_perm_b32 v31, v52, v52, v23
v_mfma_f32_16x16x32_bf16 v[40:43], v[32:35], v[140:143], v[40:43]
v_mfma_f32_16x16x32_bf16 v[44:47], v[36:39], v[140:143], v[44:47]
v_perm_b32 v32, v53, v53, v16
v_perm_b32 v33, v53, v53, v17
v_perm_b32 v34, v53, v53, v18
v_perm_b32 v35, v53, v53, v19
v_perm_b32 v36, v53, v53, v20
v_perm_b32 v37, v53, v53, v21
v_perm_b32 v38, v53, v53, v22
v_perm_b32 v39, v53, v53, v23
v_mfma_f32_16x16x32_bf16 v[40:43], v[24:27], v[144:147], v[40:43]
v_mfma_f32_16x16x32_bf16 v[44:47], v[28:31], v[144:147], v[44:47]
v_perm_b32 v24, v54, v54, v16
v_perm_b32 v25, v54, v54, v17
v_perm_b32 v26, v54, v54, v18
v_perm_b32 v27, v54, v54, v19
v_perm_b32 v28, v54, v54, v20
v_perm_b32 v29, v54, v54, v21
v_perm_b32 v30, v54, v54, v22
v_perm_b32 v31, v54, v54, v23
v_mfma_f32_16x16x32_bf16 v[40:43], v[32:35], v[148:151], v[40:43]
v_mfma_f32_16x16x32_bf16 v[44:47], v[36:39], v[148:151], v[44:47]
v_perm_b32 v32, v55, v55, v16
v_perm_b32 v33, v55, v55, v17
v_perm_b32 v34, v55, v55, v18
v_perm_b32 v35, v55, v55, v19
v_perm_b32 v36, v55, v55, v20
v_perm_b32 v37, v55, v55, v21
v_perm_b32 v38, v55, v55, v22
v_perm_b32 v39, v55, v55, v23
v_mfma_f32_16x16x32_bf16 v[40:43], v[24:27], v[152:155], v[40:43]
v_mfma_f32_16x16x32_bf16 v[44:47], v[28:31], v[152:155], v[44:47]
v_perm_b32 v24, v56, v56, v16
v_perm_b32 v25, v56, v56, v17
v_perm_b32 v26, v56, v56, v18
v_perm_b32 v27, v56, v56, v19
v_perm_b32 v28, v56, v56, v20
v_perm_b32 v29, v56, v56, v21
v_perm_b32 v30, v56, v56, v22
v_perm_b32 v31, v56, v56, v23
v_mfma_f32_16x16x32_bf16 v[40:43], v[32:35], v[156:159], v[40:43]
v_mfma_f32_16x16x32_bf16 v[44:47], v[36:39], v[156:159], v[44:47]
v_perm_b32 v32, v57, v57, v16
v_perm_b32 v33, v57, v57, v17
v_perm_b32 v34, v57, v57, v18
v_perm_b32 v35, v57, v57, v19
v_perm_b32 v36, v57, v57, v20
v_perm_b32 v37, v57, v57, v21
v_perm_b32 v38, v57, v57, v22
v_perm_b32 v39, v57, v57, v23
v_mfma_f32_16x16x32_bf16 v[40:43], v[24:27], v[160:163], v[40:43]
v_mfma_f32_16x16x32_bf16 v[44:47], v[28:31], v[160:163], v[44:47]
v_perm_b32 v24, v58, v58, v16
v_perm_b32 v25, v58, v58, v17
v_perm_b32 v26, v58, v58, v18
v_perm_b32 v27, v58, v58, v19
v_perm_b32 v28, v58, v58, v20
v_perm_b32 v29, v58, v58, v21
v_perm_b32 v30, v58, v58, v22
v_perm_b32 v31, v58, v58, v23
v_mfma_f32_16x16x32_bf16 v[40:43], v[32:35], v[164:167], v[40:43]
v_mfma_f32_16x16x32_bf16 v[44:47], v[36:39], v[164:167], v[44:47]
v_perm_b32 v32, v59, v59, v16
v_perm_b32 v33, v59, v59, v17
v_perm_b32 v34, v59, v59, v18
v_perm_b32 v35, v59, v59, v19
v_perm_b32 v36, v59, v59, v20
v_perm_b32 v37, v59, v59, v21
v_perm_b32 v38, v59, v59, v22
v_perm_b32 v39, v59, v59, v23
v_mfma_f32_16x16x32_bf16 v[40:43], v[24:27], v[168:171], v[40:43]
v_mfma_f32_16x16x32_bf16 v[44:47], v[28:31], v[168:171], v[44:47]
v_perm_b32 v24, v60, v60, v16
v_perm_b32 v25, v60, v60, v17
v_perm_b32 v26, v60, v60, v18
v_perm_b32 v27, v60, v60, v19
v_perm_b32 v28, v60, v60, v20
v_perm_b32 v29, v60, v60, v21
v_perm_b32 v30, v60, v60, v22
v_perm_b32 v31, v60, v60, v23
v_mfma_f32_16x16x32_bf16 v[40:43], v[32:35], v[172:175], v[40:43]
v_mfma_f32_16x16x32_bf16 v[44:47], v[36:39], v[172:175], v[44:47]
v_perm_b32 v32, v61, v61, v16
v_perm_b32 v33, v61, v61, v17
v_perm_b32 v34, v61, v61, v18
v_perm_b32 v35, v61, v61, v19
v_perm_b32 v36, v61, v61, v20
v_perm_b32 v37, v61, v61, v21
v_perm_b32 v38, v61, v61, v22
v_perm_b32 v39, v61, v61, v23
v_mfma_f32_16x16x32_bf16 v[40:43], v[24:27], v[176:179], v[40:43]
v_mfma_f32_16x16x32_bf16 v[44:47], v[28:31], v[176:179], v[44:47]
v_perm_b32 v24, v62, v62, v16
v_perm_b32 v25, v62, v62, v17
v_perm_b32 v26, v62, v62, v18
v_perm_b32 v27, v62, v62, v19
v_perm_b32 v28, v62, v62, v20
v_perm_b32 v29, v62, v62, v21
v_perm_b32 v30, v62, v62, v22
v_perm_b32 v31, v62, v62, v23
v_mfma_f32_16x16x32_bf16 v[40:43], v[32:35], v[180:183], v[40:43]
v_mfma_f32_16x16x32_bf16 v[44:47], v[36:39], v[180:183], v[44:47]
v_perm_b32 v32, v63, v63, v16
v_perm_b32 v33, v63, v63, v17
v_perm_b32 v34, v63, v63, v18
v_perm_b32 v35, v63, v63, v19
v_perm_b32 v36, v63, v63, v20
v_perm_b32 v37, v63, v63, v21
v_perm_b32 v38, v63, v63, v22
v_perm_b32 v39, v63, v63, v23
v_mfma_f32_16x16x32_bf16 v[40:43], v[24:27], v[184:187], v[40:43]
v_mfma_f32_16x16x32_bf16 v[44:47], v[28:31], v[184:187], v[44:47]
s_waitcnt lgkmcnt(15)
v_perm_b32 v24, v64, v64, v16
v_perm_b32 v25, v64, v64, v17
v_perm_b32 v26, v64, v64, v18
v_perm_b32 v27, v64, v64, v19
v_perm_b32 v28, v64, v64, v20
v_perm_b32 v29, v64, v64, v21
v_perm_b32 v30, v64, v64, v22
v_perm_b32 v31, v64, v64, v23
v_mfma_f32_16x16x32_bf16 v[40:43], v[32:35], v[188:191], v[40:43]
v_mfma_f32_16x16x32_bf16 v[44:47], v[36:39], v[188:191], v[44:47]
s_waitcnt lgkmcnt(14)
v_perm_b32 v32, v65, v65, v16
v_perm_b32 v33, v65, v65, v17
v_perm_b32 v34, v65, v65, v18
v_perm_b32 v35, v65, v65, v19
v_perm_b32 v36, v65, v65, v20
v_perm_b32 v37, v65, v65, v21
v_perm_b32 v38, v65, v65, v22
v_perm_b32 v39, v65, v65, v23
v_mfma_f32_16x16x32_bf16 v[40:43], v[24:27], v[192:195], v[40:43]
v_mfma_f32_16x16x32_bf16 v[44:47], v[28:31], v[192:195], v[44:47]
s_waitcnt lgkmcnt(13)
v_perm_b32 v24, v66, v66, v16
v_perm_b32 v25, v66, v66, v17
v_perm_b32 v26, v66, v66, v18
v_perm_b32 v27, v66, v66, v19
v_perm_b32 v28, v66, v66, v20
v_perm_b32 v29, v66, v66, v21
v_perm_b32 v30, v66, v66, v22
v_perm_b32 v31, v66, v66, v23
v_mfma_f32_16x16x32_bf16 v[40:43], v[32:35], v[196:199], v[40:43]
v_mfma_f32_16x16x32_bf16 v[44:47], v[36:39], v[196:199], v[44:47]
s_waitcnt lgkmcnt(12)
v_perm_b32 v32, v67, v67, v16
v_perm_b32 v33, v67, v67, v17
v_perm_b32 v34, v67, v67, v18
v_perm_b32 v35, v67, v67, v19
v_perm_b32 v36, v67, v67, v20
v_perm_b32 v37, v67, v67, v21
v_perm_b32 v38, v67, v67, v22
v_perm_b32 v39, v67, v67, v23
v_mfma_f32_16x16x32_bf16 v[40:43], v[24:27], v[200:203], v[40:43]
v_mfma_f32_16x16x32_bf16 v[44:47], v[28:31], v[200:203], v[44:47]
s_waitcnt lgkmcnt(11)
v_perm_b32 v24, v68, v68, v16
v_perm_b32 v25, v68, v68, v17
v_perm_b32 v26, v68, v68, v18
v_perm_b32 v27, v68, v68, v19
v_perm_b32 v28, v68, v68, v20
v_perm_b32 v29, v68, v68, v21
v_perm_b32 v30, v68, v68, v22
v_perm_b32 v31, v68, v68, v23
v_mfma_f32_16x16x32_bf16 v[40:43], v[32:35], v[204:207], v[40:43]
v_mfma_f32_16x16x32_bf16 v[44:47], v[36:39], v[204:207], v[44:47]
s_waitcnt lgkmcnt(10)
v_perm_b32 v32, v69, v69, v16
v_perm_b32 v33, v69, v69, v17
v_perm_b32 v34, v69, v69, v18
v_perm_b32 v35, v69, v69, v19
v_perm_b32 v36, v69, v69, v20
v_perm_b32 v37, v69, v69, v21
v_perm_b32 v38, v69, v69, v22
v_perm_b32 v39, v69, v69, v23
v_mfma_f32_16x16x32_bf16 v[40:43], v[24:27], v[208:211], v[40:43]
v_mfma_f32_16x16x32_bf16 v[44:47], v[28:31], v[208:211], v[44:47]
s_waitcnt lgkmcnt(9)
v_perm_b32 v24, v70, v70, v16
v_perm_b32 v25, v70, v70, v17
v_perm_b32 v26, v70, v70, v18
v_perm_b32 v27, v70, v70, v19
v_perm_b32 v28, v70, v70, v20
v_perm_b32 v29, v70, v70, v21
v_perm_b32 v30, v70, v70, v22
v_perm_b32 v31, v70, v70, v23
v_mfma_f32_16x16x32_bf16 v[40:43], v[32:35], v[212:215], v[40:43]
v_mfma_f32_16x16x32_bf16 v[44:47], v[36:39], v[212:215], v[44:47]
s_waitcnt lgkmcnt(8)
v_perm_b32 v32, v71, v71, v16
v_perm_b32 v33, v71, v71, v17
v_perm_b32 v34, v71, v71, v18
v_perm_b32 v35, v71, v71, v19
v_perm_b32 v36, v71, v71, v20
v_perm_b32 v37, v71, v71, v21
v_perm_b32 v38, v71, v71, v22
v_perm_b32 v39, v71, v71, v23
v_mfma_f32_16x16x32_bf16 v[40:43], v[24:27], v[216:219], v[40:43]
v_mfma_f32_16x16x32_bf16 v[44:47], v[28:31], v[216:219], v[44:47]
s_waitcnt lgkmcnt(7)
v_perm_b32 v24, v72, v72, v16
v_perm_b32 v25, v72, v72, v17
v_perm_b32 v26, v72, v72, v18
v_perm_b32 v27, v72, v72, v19
v_perm_b32 v28, v72, v72, v20
v_perm_b32 v29, v72, v72, v21
v_perm_b32 v30, v72, v72, v22
v_perm_b32 v31, v72, v72, v23
v_mfma_f32_16x16x32_bf16 v[40:43], v[32:35], v[220:223], v[40:43]
v_mfma_f32_16x16x32_bf16 v[44:47], v[36:39], v[220:223], v[44:47]
s_waitcnt lgkmcnt(6)
v_perm_b32 v32, v73, v73, v16
v_perm_b32 v33, v73, v73, v17
v_perm_b32 v34, v73, v73, v18
v_perm_b32 v35, v73, v73, v19
v_perm_b32 v36, v73, v73, v20
v_perm_b32 v37, v73, v73, v21
v_perm_b32 v38, v73, v73, v22
v_perm_b32 v39, v73, v73, v23
v_mfma_f32_16x16x32_bf16 v[40:43], v[24:27], v[224:227], v[40:43]
v_mfma_f32_16x16x32_bf16 v[44:47], v[28:31], v[224:227], v[44:47]
s_waitcnt lgkmcnt(5)
v_perm_b32 v24, v74, v74, v16
v_perm_b32 v25, v74, v74, v17
v_perm_b32 v26, v74, v74, v18
v_perm_b32 v27, v74, v74, v19
v_perm_b32 v28, v74, v74, v20
v_perm_b32 v29, v74, v74, v21
v_perm_b32 v30, v74, v74, v22
v_perm_b32 v31, v74, v74, v23
v_mfma_f32_16x16x32_bf16 v[40:43], v[32:35], v[228:231], v[40:43]
v_mfma_f32_16x16x32_bf16 v[44:47], v[36:39], v[228:231], v[44:47]
s_waitcnt lgkmcnt(4)
v_perm_b32 v32, v75, v75, v16
v_perm_b32 v33, v75, v75, v17
v_perm_b32 v34, v75, v75, v18
v_perm_b32 v35, v75, v75, v19
v_perm_b32 v36, v75, v75, v20
v_perm_b32 v37, v75, v75, v21
v_perm_b32 v38, v75, v75, v22
v_perm_b32 v39, v75, v75, v23
v_mfma_f32_16x16x32_bf16 v[40:43], v[24:27], v[232:235], v[40:43]
v_mfma_f32_16x16x32_bf16 v[44:47], v[28:31], v[232:235], v[44:47]
s_waitcnt lgkmcnt(3)
v_perm_b32 v24, v76, v76, v16
v_perm_b32 v25, v76, v76, v17
v_perm_b32 v26, v76, v76, v18
v_perm_b32 v27, v76, v76, v19
v_perm_b32 v28, v76, v76, v20
v_perm_b32 v29, v76, v76, v21
v_perm_b32 v30, v76, v76, v22
v_perm_b32 v31, v76, v76, v23
v_mfma_f32_16x16x32_bf16 v[40:43], v[32:35], v[236:239], v[40:43]
v_mfma_f32_16x16x32_bf16 v[44:47], v[36:39], v[236:239], v[44:47]
s_waitcnt lgkmcnt(2)
v_perm_b32 v32, v77, v77, v16
v_perm_b32 v33, v77, v77, v17
v_perm_b32 v34, v77, v77, v18
v_perm_b32 v35, v77, v77, v19
v_perm_b32 v36, v77, v77, v20
v_perm_b32 v37, v77, v77, v21
v_perm_b32 v38, v77, v77, v22
v_perm_b32 v39, v77, v77, v23
v_mfma_f32_16x16x32_bf16 v[40:43], v[24:27], v[240:243], v[40:43]
v_mfma_f32_16x16x32_bf16 v[44:47], v[28:31], v[240:243], v[44:47]
s_waitcnt lgkmcnt(1)
v_perm_b32 v24, v78, v78, v16
v_perm_b32 v25, v78, v78, v17
v_perm_b32 v26, v78, v78, v18
v_perm_b32 v27, v78, v78, v19
v_perm_b32 v28, v78, v78, v20
v_perm_b32 v29, v78, v78, v21
v_perm_b32 v30, v78, v78, v22
v_perm_b32 v31, v78, v78, v23
v_mfma_f32_16x16x32_bf16 v[40:43], v[32:35], v[244:247], v[40:43]
v_mfma_f32_16x16x32_bf16 v[44:47], v[36:39], v[244:247], v[44:47]
s_waitcnt lgkmcnt(0)
v_perm_b32 v32, v79, v79, v16
v_perm_b32 v33, v79, v79, v17
v_perm_b32 v34, v79, v79, v18
v_perm_b32 v35, v79, v79, v19
v_perm_b32 v36, v79, v79, v20
v_perm_b32 v37, v79, v79, v21
v_perm_b32 v38, v79, v79, v22
v_perm_b32 v39, v79, v79, v23
v_mfma_f32_16x16x32_bf16 v[40:43], v[24:27], v[248:251], v[40:43]
v_mfma_f32_16x16x32_bf16 v[44:47], v[28:31], v[248:251], v[44:47]
v_mfma_f32_16x16x32_bf16 v[40:43], v[32:35], v[252:255], v[40:43]
v_mfma_f32_16x16x32_bf16 v[44:47], v[36:39], v[252:255], v[44:47]
s_nop 7
v_add_f32_dpp v40, v44, v40 row_ror:8 row_mask:0xf bank_mask:0xf
v_add_f32_dpp v41, v45, v41 row_ror:8 row_mask:0xf bank_mask:0xf
v_add_f32_dpp v42, v46, v42 row_ror:8 row_mask:0xf bank_mask:0xf
v_add_f32_dpp v43, v47, v43 row_ror:8 row_mask:0xf bank_mask:0xf
v_min_u32 v40, -2, v40
v_min_u32 v41, -2, v41
v_min_u32 v42, -2, v42
v_min_u32 v43, -2, v43
s_mov_b64 exec, s[56:57]
buffer_store_dwordx4 v[40:43], v5, s[40:43], s67 offen sc1
s_mov_b64 exec, -1
s_nop 0
L_nodown_24:
s_cmp_eq_u32 s73, 0
s_cbranch_scc1 L_f_nowo
s_mov_b32 s44, s24
s_and_b32 s45, s25, 0xffff
s_mov_b32 s46, 4718592
s_mov_b32 s47, 0x20000
v_mul_u32_u24 v3, 1152, v1
v_add_u32 v3, v3, v2
s_mul_i32 s69, s76, 294912
s_lshl_b32 s58, s77, 7
s_add_u32 s69, s69, s58
buffer_load_dwordx4 v[128:131], v3, s[44:47], s69 offen nt
s_add_u32 s69, s69, 9216
buffer_load_dwordx4 v[132:135], v3, s[44:47], s69 offen nt
s_add_u32 s69, s69, 9216
buffer_load_dwordx4 v[136:139], v3, s[44:47], s69 offen nt
s_add_u32 s69, s69, 9216
buffer_load_dwordx4 v[140:143], v3, s[44:47], s69 offen nt
s_add_u32 s69, s69, 9216
buffer_load_dwordx4 v[144:147], v3, s[44:47], s69 offen nt
s_add_u32 s69, s69, 9216
buffer_load_dwordx4 v[148:151], v3, s[44:47], s69 offen nt
s_add_u32 s69, s69, 9216
buffer_load_dwordx4 v[152:155], v3, s[44:47], s69 offen nt
s_add_u32 s69, s69, 9216
buffer_load_dwordx4 v[156:159], v3, s[44:47], s69 offen nt
s_add_u32 s69, s69, 9216
buffer_load_dwordx4 v[160:163], v3, s[44:47], s69 offen nt
s_add_u32 s69, s69, 9216
buffer_load_dwordx4 v[164:167], v3, s[44:47], s69 offen nt
s_add_u32 s69, s69, 9216
buffer_load_dwordx4 v[168:171], v3, s[44:47], s69 offen nt
s_add_u32 s69, s69, 9216
buffer_load_dwordx4 v[172:175], v3, s[44:47], s69 offen nt
s_add_u32 s69, s69, 9216
buffer_load_dwordx4 v[176:179], v3, s[44:47], s69 offen nt
s_add_u32 s69, s69, 9216
buffer_load_dwordx4 v[180:183], v3, s[44:47], s69 offen nt
s_add_u32 s69, s69, 9216
buffer_load_dwordx4 v[184:187], v3, s[44:47], s69 offen nt
s_add_u32 s69, s69, 9216
buffer_load_dwordx4 v[188:191], v3, s[44:47], s69 offen nt
v_lshrrev_b32 v9, 5, v0
v_and_b32 v10, 31, v0
v_lshlrev_b32 v14, 17, v9
v_lshl_add_u32 v14, v10, 4, v14
v_lshlrev_b32 v15, 11, v9
v_lshlrev_b32 v13, 9, v9
v_and_b32 v10, 15, v0
v_lshl_add_u32 v13, v10, 4, v13
v_bfe_u32 v10, v0, 4, 1
v_lshl_add_u32 v13, v10, 3, v13
s_waitcnt vmcnt(0)
ds_write_b128 v6, v[128:131] offset:9216
ds_write_b128 v6, v[132:135] offset:10240
ds_write_b128 v6, v[136:139] offset:11264
ds_write_b128 v6, v[140:143] offset:12288
ds_write_b128 v6, v[144:147] offset:13312
ds_write_b128 v6, v[148:151] offset:14336
ds_write_b128 v6, v[152:155] offset:15360
ds_write_b128 v6, v[156:159] offset:16384
ds_write_b128 v6, v[160:163] offset:17408
ds_write_b128 v6, v[164:167] offset:18432
ds_write_b128 v6, v[168:171] offset:19456
ds_write_b128 v6, v[172:175] offset:20480
ds_write_b128 v6, v[176:179] offset:21504
ds_write_b128 v6, v[180:183] offset:22528
ds_write_b128 v6, v[184:187] offset:23552
ds_write_b128 v6, v[188:191] offset:24576
v_and_b32 v10, 15, v0
v_lshlrev_b32 v10, 1, v10
v_lshl_add_u32 v12, v4, 8, v10
ds_read_u16 v24, v12 offset:9216
ds_read_u16 v25, v12 offset:9344
ds_read_u16 v26, v12 offset:9472
ds_read_u16 v27, v12 offset:9600
ds_read_u16 v28, v12 offset:9728
ds_read_u16 v29, v12 offset:9856
ds_read_u16 v30, v12 offset:9984
ds_read_u16 v31, v12 offset:10112
s_waitcnt lgkmcnt(0)
v_lshl_or_b32 v192, v25, 16, v24
v_lshl_or_b32 v193, v27, 16, v26
v_lshl_or_b32 v194, v29, 16, v28
v_lshl_or_b32 v195, v31, 16, v30
ds_read_u16 v24, v12 offset:9248
ds_read_u16 v25, v12 offset:9376
ds_read_u16 v26, v12 offset:9504
ds_read_u16 v27, v12 offset:9632
ds_read_u16 v28, v12 offset:9760
ds_read_u16 v29, v12 offset:9888
ds_read_u16 v30, v12 offset:10016
ds_read_u16 v31, v12 offset:10144
s_waitcnt lgkmcnt(0)
v_lshl_or_b32 v196, v25, 16, v24
v_lshl_or_b32 v197, v27, 16, v26
v_lshl_or_b32 v198, v29, 16, v28
v_lshl_or_b32 v199, v31, 16, v30
ds_read_u16 v24, v12 offset:9280
ds_read_u16 v25, v12 offset:9408
ds_read_u16 v26, v12 offset:9536
ds_read_u16 v27, v12 offset:9664
ds_read_u16 v28, v12 offset:9792
ds_read_u16 v29, v12 offset:9920
ds_read_u16 v30, v12 offset:10048
ds_read_u16 v31, v12 offset:10176
s_waitcnt lgkmcnt(0)
v_lshl_or_b32 v200, v25, 16, v24
v_lshl_or_b32 v201, v27, 16, v26
v_lshl_or_b32 v202, v29, 16, v28
v_lshl_or_b32 v203, v31, 16, v30
ds_read_u16 v24, v12 offset:9312
ds_read_u16 v25, v12 offset:9440
ds_read_u16 v26, v12 offset:9568
ds_read_u16 v27, v12 offset:9696
ds_read_u16 v28, v12 offset:9824
ds_read_u16 v29, v12 offset:9952
ds_read_u16 v30, v12 offset:10080
ds_read_u16 v31, v12 offset:10208
s_waitcnt lgkmcnt(0)
v_lshl_or_b32 v204, v25, 16, v24
v_lshl_or_b32 v205, v27, 16, v26
v_lshl_or_b32 v206, v29, 16, v28
v_lshl_or_b32 v207, v31, 16, v30
ds_read_u16 v24, v12 offset:13312
ds_read_u16 v25, v12 offset:13440
ds_read_u16 v26, v12 offset:13568
ds_read_u16 v27, v12 offset:13696
ds_read_u16 v28, v12 offset:13824
ds_read_u16 v29, v12 offset:13952
ds_read_u16 v30, v12 offset:14080
ds_read_u16 v31, v12 offset:14208
s_waitcnt lgkmcnt(0)
v_lshl_or_b32 v208, v25, 16, v24
v_lshl_or_b32 v209, v27, 16, v26
v_lshl_or_b32 v210, v29, 16, v28
v_lshl_or_b32 v211, v31, 16, v30
ds_read_u16 v24, v12 offset:13344
ds_read_u16 v25, v12 offset:13472
ds_read_u16 v26, v12 offset:13600
ds_read_u16 v27, v12 offset:13728
ds_read_u16 v28, v12 offset:13856
ds_read_u16 v29, v12 offset:13984
ds_read_u16 v30, v12 offset:14112
ds_read_u16 v31, v12 offset:14240
s_waitcnt lgkmcnt(0)
v_lshl_or_b32 v212, v25, 16, v24
v_lshl_or_b32 v213, v27, 16, v26
v_lshl_or_b32 v214, v29, 16, v28
v_lshl_or_b32 v215, v31, 16, v30
ds_read_u16 v24, v12 offset:13376
ds_read_u16 v25, v12 offset:13504
ds_read_u16 v26, v12 offset:13632
ds_read_u16 v27, v12 offset:13760
ds_read_u16 v28, v12 offset:13888
ds_read_u16 v29, v12 offset:14016
ds_read_u16 v30, v12 offset:14144
ds_read_u16 v31, v12 offset:14272
s_waitcnt lgkmcnt(0)
v_lshl_or_b32 v216, v25, 16, v24
v_lshl_or_b32 v217, v27, 16, v26
v_lshl_or_b32 v218, v29, 16, v28
v_lshl_or_b32 v219, v31, 16, v30
ds_read_u16 v24, v12 offset:13408
ds_read_u16 v25, v12 offset:13536
ds_read_u16 v26, v12 offset:13664
ds_read_u16 v27, v12 offset:13792
ds_read_u16 v28, v12 offset:13920
ds_read_u16 v29, v12 offset:14048
ds_read_u16 v30, v12 offset:14176
ds_read_u16 v31, v12 offset:14304
s_waitcnt lgkmcnt(0)
v_lshl_or_b32 v220, v25, 16, v24
v_lshl_or_b32 v221, v27, 16, v26
v_lshl_or_b32 v222, v29, 16, v28
v_lshl_or_b32 v223, v31, 16, v30
ds_read_u16 v24, v12 offset:17408
ds_read_u16 v25, v12 offset:17536
ds_read_u16 v26, v12 offset:17664
ds_read_u16 v27, v12 offset:17792
ds_read_u16 v28, v12 offset:17920
ds_read_u16 v29, v12 offset:18048
ds_read_u16 v30, v12 offset:18176
ds_read_u16 v31, v12 offset:18304
s_waitcnt lgkmcnt(0)
v_lshl_or_b32 v224, v25, 16, v24
v_lshl_or_b32 v225, v27, 16, v26
v_lshl_or_b32 v226, v29, 16, v28
v_lshl_or_b32 v227, v31, 16, v30
ds_read_u16 v24, v12 offset:17440
ds_read_u16 v25, v12 offset:17568
ds_read_u16 v26, v12 offset:17696
ds_read_u16 v27, v12 offset:17824
ds_read_u16 v28, v12 offset:17952
ds_read_u16 v29, v12 offset:18080
ds_read_u16 v30, v12 offset:18208
ds_read_u16 v31, v12 offset:18336
s_waitcnt lgkmcnt(0)
v_lshl_or_b32 v228, v25, 16, v24
v_lshl_or_b32 v229, v27, 16, v26
v_lshl_or_b32 v230, v29, 16, v28
v_lshl_or_b32 v231, v31, 16, v30
ds_read_u16 v24, v12 offset:17472
ds_read_u16 v25, v12 offset:17600
ds_read_u16 v26, v12 offset:17728
ds_read_u16 v27, v12 offset:17856
ds_read_u16 v28, v12 offset:17984
ds_read_u16 v29, v12 offset:18112
ds_read_u16 v30, v12 offset:18240
ds_read_u16 v31, v12 offset:18368
s_waitcnt lgkmcnt(0)
v_lshl_or_b32 v232, v25, 16, v24
v_lshl_or_b32 v233, v27, 16, v26
v_lshl_or_b32 v234, v29, 16, v28
v_lshl_or_b32 v235, v31, 16, v30
ds_read_u16 v24, v12 offset:17504
ds_read_u16 v25, v12 offset:17632
ds_read_u16 v26, v12 offset:17760
ds_read_u16 v27, v12 offset:17888
ds_read_u16 v28, v12 offset:18016
ds_read_u16 v29, v12 offset:18144
ds_read_u16 v30, v12 offset:18272
ds_read_u16 v31, v12 offset:18400
s_waitcnt lgkmcnt(0)
v_lshl_or_b32 v236, v25, 16, v24
v_lshl_or_b32 v237, v27, 16, v26
v_lshl_or_b32 v238, v29, 16, v28
v_lshl_or_b32 v239, v31, 16, v30
ds_read_u16 v24, v12 offset:21504
ds_read_u16 v25, v12 offset:21632
ds_read_u16 v26, v12 offset:21760
ds_read_u16 v27, v12 offset:21888
ds_read_u16 v28, v12 offset:22016
ds_read_u16 v29, v12 offset:22144
ds_read_u16 v30, v12 offset:22272
ds_read_u16 v31, v12 offset:22400
s_waitcnt lgkmcnt(0)
v_lshl_or_b32 v240, v25, 16, v24
v_lshl_or_b32 v241, v27, 16, v26
v_lshl_or_b32 v242, v29, 16, v28
v_lshl_or_b32 v243, v31, 16, v30
ds_read_u16 v24, v12 offset:21536
ds_read_u16 v25, v12 offset:21664
ds_read_u16 v26, v12 offset:21792
ds_read_u16 v27, v12 offset:21920
ds_read_u16 v28, v12 offset:22048
ds_read_u16 v29, v12 offset:22176
ds_read_u16 v30, v12 offset:22304
ds_read_u16 v31, v12 offset:22432
s_waitcnt lgkmcnt(0)
v_lshl_or_b32 v244, v25, 16, v24
v_lshl_or_b32 v245, v27, 16, v26
v_lshl_or_b32 v246, v29, 16, v28
v_lshl_or_b32 v247, v31, 16, v30
ds_read_u16 v24, v12 offset:21568
ds_read_u16 v25, v12 offset:21696
ds_read_u16 v26, v12 offset:21824
ds_read_u16 v27, v12 offset:21952
ds_read_u16 v28, v12 offset:22080
ds_read_u16 v29, v12 offset:22208
ds_read_u16 v30, v12 offset:22336
ds_read_u16 v31, v12 offset:22464
s_waitcnt lgkmcnt(0)
v_lshl_or_b32 v248, v25, 16, v24
v_lshl_or_b32 v249, v27, 16, v26
v_lshl_or_b32 v250, v29, 16, v28
v_lshl_or_b32 v251, v31, 16, v30
ds_read_u16 v24, v12 offset:21600
ds_read_u16 v25, v12 offset:21728
ds_read_u16 v26, v12 offset:21856
ds_read_u16 v27, v12 offset:21984
ds_read_u16 v28, v12 offset:22112
ds_read_u16 v29, v12 offset:22240
ds_read_u16 v30, v12 offset:22368
ds_read_u16 v31, v12 offset:22496
s_waitcnt lgkmcnt(0)
v_lshl_or_b32 v252, v25, 16, v24
v_lshl_or_b32 v253, v27, 16, v26
v_lshl_or_b32 v254, v29, 16, v28
v_lshl_or_b32 v255, v31, 16, v30
v_and_b32 v10, 1, v0
v_lshlrev_b32 v10, 9, v10
v_lshl_add_u32 v12, v4, 2, v10
v_lshlrev_b32 v5, 3, v0
s_lshl_b32 s87, s76, 13
s_add_u32 s87, s87, 147456
s_add_u32 s88, s87, 4096
s_lshl_b32 s89, s76, 7
s_add_u32 s89, s89, 409600
s_mov_b32 s94, 0
s_mov_b32 s62, 8000000
L_ld_27:
ds_read_b32 v9, v8 offset:9024
s_waitcnt lgkmcnt(0)
v_cmp_ne_u32 vcc, 4, v9
s_nop 3
s_cbranch_vccz L_ldd_28
s_sleep 1
s_sub_u32 s62, s62, 1
s_cmp_lg_u32 s62, 0
s_cbranch_scc1 L_ld_27
L_ldd_28:
L_f_tail:
s_mov_b32 s62, 1000000
L_poll_29:
buffer_load_dwordx2 v[56:57], v15, s[40:43], s89 offen offset:0 sc1
buffer_load_dwordx2 v[58:59], v15, s[40:43], s89 offen offset:16 sc1
buffer_load_dwordx2 v[60:61], v15, s[40:43], s89 offen offset:32 sc1
buffer_load_dwordx2 v[62:63], v15, s[40:43], s89 offen offset:48 sc1
buffer_load_dwordx2 v[64:65], v15, s[40:43], s89 offen offset:64 sc1
buffer_load_dwordx2 v[66:67], v15, s[40:43], s89 offen offset:80 sc1
buffer_load_dwordx2 v[68:69], v15, s[40:43], s89 offen offset:96 sc1
buffer_load_dwordx2 v[70:71], v15, s[40:43], s89 offen offset:112 sc1
buffer_load_dwordx4 v[24:27], v14, s[40:43], s87 offen offset:0 sc1
buffer_load_dwordx4 v[28:31], v14, s[40:43], s87 offen offset:1024 sc1
buffer_load_dwordx4 v[32:35], v14, s[40:43], s87 offen offset:2048 sc1
buffer_load_dwordx4 v[36:39], v14, s[40:43], s87 offen offset:3072 sc1
buffer_load_dwordx4 v[40:43], v14, s[40:43], s88 offen offset:0 sc1
buffer_load_dwordx4 v[44:47], v14, s[40:43], s88 offen offset:1024 sc1
buffer_load_dwordx4 v[48:51], v14, s[40:43], s88 offen offset:2048 sc1
buffer_load_dwordx4 v[52:55], v14, s[40:43], s88 offen offset:3072 sc1
s_waitcnt vmcnt(0)
v_max3_u32 v9, v24, v25, v26
v_max3_u32 v9, v9, v27, v28
v_max3_u32 v9, v9, v29, v30
v_max3_u32 v9, v9, v31, v32
v_max3_u32 v9, v9, v33, v34
v_max3_u32 v9, v9, v35, v36
v_max3_u32 v9, v9, v37, v38
v_max3_u32 v9, v9, v39, v40
v_max3_u32 v9, v9, v41, v42
v_max3_u32 v9, v9, v43, v44
v_max3_u32 v9, v9, v45, v46
v_max3_u32 v9, v9, v47, v48
v_max3_u32 v9, v9, v49, v50
v_max3_u32 v9, v9, v51, v52
v_max3_u32 v9, v9, v53, v54
v_max3_u32 v9, v9, v55, v56
v_max3_u32 v9, v9, v57, v58
v_max3_u32 v9, v9, v59, v60
v_max3_u32 v9, v9, v61, v62
v_max3_u32 v9, v9, v63, v64
v_max3_u32 v9, v9, v65, v66
v_max3_u32 v9, v9, v67, v68
v_max3_u32 v9, v9, v69, v70
v_max_u32 v9, v9, v71
v_cmp_eq_u32 vcc, -1, v9
s_nop 3
s_cbranch_vccz L_polld_30
s_sleep 1
s_sub_u32 s62, s62, 1
s_cmp_lg_u32 s62, 0
s_cbranch_scc1 L_poll_29
L_polld_30:
v_max3_f32 v120, v56, v58, v60
v_max3_f32 v120, v120, v62, v64
v_max3_f32 v120, v120, v66, v68
v_max_f32 v120, v120, v70
v_sub_f32 v56, v56, v120
v_mul_f32 v56, s70, v56
v_sub_f32 v58, v58, v120
v_mul_f32 v58, s70, v58
v_sub_f32 v60, v60, v120
v_mul_f32 v60, s70, v60
v_sub_f32 v62, v62, v120
v_mul_f32 v62, s70, v62
v_sub_f32 v64, v64, v120
v_mul_f32 v64, s70, v64
v_sub_f32 v66, v66, v120
v_mul_f32 v66, s70, v66
v_sub_f32 v68, v68, v120
v_mul_f32 v68, s70, v68
v_sub_f32 v70, v70, v120
v_mul_f32 v70, s70, v70
v_exp_f32 v56, v56
v_exp_f32 v58, v58
v_exp_f32 v60, v60
v_exp_f32 v62, v62
v_exp_f32 v64, v64
v_exp_f32 v66, v66
v_exp_f32 v68, v68
v_exp_f32 v70, v70
v_mul_f32 v121, v56, v57
v_mul_f32 v124, v56, v24
v_mul_f32 v125, v56, v25
v_mul_f32 v126, v56, v26
v_mul_f32 v127, v56, v27
v_fmac_f32 v121, v58, v59
v_fmac_f32 v124, v58, v28
v_fmac_f32 v125, v58, v29
v_fmac_f32 v126, v58, v30
v_fmac_f32 v127, v58, v31
v_fmac_f32 v121, v60, v61
v_fmac_f32 v124, v60, v32
v_fmac_f32 v125, v60, v33
v_fmac_f32 v126, v60, v34
v_fmac_f32 v127, v60, v35
v_fmac_f32 v121, v62, v63
v_fmac_f32 v124, v62, v36
v_fmac_f32 v125, v62, v37
v_fmac_f32 v126, v62, v38
v_fmac_f32 v127, v62, v39
v_fmac_f32 v121, v64, v65
v_fmac_f32 v124, v64, v40
v_fmac_f32 v125, v64, v41
v_fmac_f32 v126, v64, v42
v_fmac_f32 v127, v64, v43
v_fmac_f32 v121, v66, v67
v_fmac_f32 v124, v66, v44
v_fmac_f32 v125, v66, v45
v_fmac_f32 v126, v66, v46
v_fmac_f32 v127, v66, v47
v_fmac_f32 v121, v68, v69
v_fmac_f32 v124, v68, v48
v_fmac_f32 v125, v68, v49
v_fmac_f32 v126, v68, v50
v_fmac_f32 v127, v68, v51
v_fmac_f32 v121, v70, v71
v_fmac_f32 v124, v70, v52
v_fmac_f32 v125, v70, v53
v_fmac_f32 v126, v70, v54
v_fmac_f32 v127, v70, v55
v_rcp_f32 v9, v121
s_nop 0
v_mul_f32 v10, v124, v9
v_fma_f32 v11, -v10, v121, v124
v_fma_f32 v124, v11, v9, v10
v_mul_f32 v10, v125, v9
v_fma_f32 v11, -v10, v121, v125
v_fma_f32 v125, v11, v9, v10
v_mul_f32 v10, v126, v9
v_fma_f32 v11, -v10, v121, v126
v_fma_f32 v126, v11, v9, v10
v_mul_f32 v10, v127, v9
v_fma_f32 v11, -v10, v121, v127
v_fma_f32 v127, v11, v9, v10
v_cvt_pk_bf16_f32 v122, v124, v125
v_cvt_pk_bf16_f32 v123, v126, v127
ds_write_b64 v13, v[122:123] offset:2816
ds_read_b128 v[24:27], v12 offset:2816
ds_read_b128 v[28:31], v12 offset:2880
ds_read_b128 v[32:35], v12 offset:2944
ds_read_b128 v[36:39], v12 offset:3008
s_waitcnt lgkmcnt(3)
v_mfma_f32_16x16x32_bf16 v[40:43], v[24:27], v[192:195], 0
v_mfma_f32_16x16x32_bf16 v[44:47], v[24:27], v[196:199], 0
v_mfma_f32_16x16x32_bf16 v[48:51], v[24:27], v[200:203], 0
v_mfma_f32_16x16x32_bf16 v[52:55], v[24:27], v[204:207], 0
s_waitcnt lgkmcnt(2)
v_mfma_f32_16x16x32_bf16 v[40:43], v[28:31], v[208:211], v[40:43]
v_mfma_f32_16x16x32_bf16 v[44:47], v[28:31], v[212:215], v[44:47]
v_mfma_f32_16x16x32_bf16 v[48:51], v[28:31], v[216:219], v[48:51]
v_mfma_f32_16x16x32_bf16 v[52:55], v[28:31], v[220:223], v[52:55]
s_waitcnt lgkmcnt(1)
v_mfma_f32_16x16x32_bf16 v[40:43], v[32:35], v[224:227], v[40:43]
v_mfma_f32_16x16x32_bf16 v[44:47], v[32:35], v[228:231], v[44:47]
v_mfma_f32_16x16x32_bf16 v[48:51], v[32:35], v[232:235], v[48:51]
v_mfma_f32_16x16x32_bf16 v[52:55], v[32:35], v[236:239], v[52:55]
s_waitcnt lgkmcnt(0)
v_mfma_f32_16x16x32_bf16 v[40:43], v[36:39], v[240:243], v[40:43]
v_mfma_f32_16x16x32_bf16 v[44:47], v[36:39], v[244:247], v[44:47]
v_mfma_f32_16x16x32_bf16 v[48:51], v[36:39], v[248:251], v[48:51]
v_mfma_f32_16x16x32_bf16 v[52:55], v[36:39], v[252:255], v[52:55]
s_mov_b64 exec, 0xffff
s_nop 3
v_min_u32 v40, -2, v40
v_min_u32 v41, -2, v41
buffer_store_dwordx2 v[40:41], v5, s[40:43], s68 offen offset:0 sc1
v_min_u32 v44, -2, v44
v_min_u32 v45, -2, v45
buffer_store_dwordx2 v[44:45], v5, s[40:43], s68 offen offset:128 sc1
v_min_u32 v48, -2, v48
v_min_u32 v49, -2, v49
buffer_store_dwordx2 v[48:49], v5, s[40:43], s68 offen offset:256 sc1
v_min_u32 v52, -2, v52
v_min_u32 v53, -2, v53
buffer_store_dwordx2 v[52:53], v5, s[40:43], s68 offen offset:384 sc1
s_mov_b64 exec, -1
s_endpgm
L_f_nowo:
s_cmp_eq_u32 s71, 0
s_cbranch_scc1 L_end
s_mov_b32 s48, s16
s_and_b32 s49, s17, 0xffff
s_mov_b32 s50, 2304
s_mov_b32 s51, 0x20000
s_add_u32 s58, s80, 16384
s_add_u32 s59, s80, 20480
s_add_u32 s60, s80, 24576
s_mov_b32 s62, 1000000
L_poll_31:
buffer_load_dwordx4 v[128:131], v6, s[40:43], s58 offen offset:0 sc1
buffer_load_dwordx4 v[132:135], v6, s[40:43], s58 offen offset:1024 sc1
buffer_load_dwordx4 v[136:139], v6, s[40:43], s58 offen offset:2048 sc1
buffer_load_dwordx4 v[140:143], v6, s[40:43], s58 offen offset:3072 sc1
buffer_load_dwordx4 v[144:147], v6, s[40:43], s59 offen offset:0 sc1
buffer_load_dwordx4 v[148:151], v6, s[40:43], s59 offen offset:1024 sc1
buffer_load_dwordx4 v[152:155], v6, s[40:43], s59 offen offset:2048 sc1
buffer_load_dwordx4 v[156:159], v6, s[40:43], s59 offen offset:3072 sc1
buffer_load_dwordx4 v[160:163], v6, s[40:43], s60 offen offset:0 sc1
s_waitcnt vmcnt(0)
v_max3_u32 v9, v128, v129, v130
v_max3_u32 v9, v9, v131, v132
v_max3_u32 v9, v9, v133, v134
v_max3_u32 v9, v9, v135, v136
v_max3_u32 v9, v9, v137, v138
v_max3_u32 v9, v9, v139, v140
v_max3_u32 v9, v9, v141, v142
v_max3_u32 v9, v9, v143, v144
v_max3_u32 v9, v9, v145, v146
v_max3_u32 v9, v9, v147, v148
v_max3_u32 v9, v9, v149, v150
v_max3_u32 v9, v9, v151, v152
v_max3_u32 v9, v9, v153, v154
v_max3_u32 v9, v9, v155, v156
v_max3_u32 v9, v9, v157, v158
v_max3_u32 v9, v9, v159, v160
v_max3_u32 v9, v9, v161, v162
v_max_u32 v9, v9, v163
v_cmp_eq_u32 vcc, -1, v9
s_nop 3
s_cbranch_vccz L_polld_32
s_sleep 32
s_sub_u32 s62, s62, 1
s_cmp_lg_u32 s62, 0
s_cbranch_scc1 L_poll_31
L_polld_32:
v_add_f32 v128, v128, v132
v_add_f32 v129, v129, v133
v_add_f32 v130, v130, v134
v_add_f32 v131, v131, v135
v_add_f32 v128, v128, v136
v_add_f32 v129, v129, v137
v_add_f32 v130, v130, v138
v_add_f32 v131, v131, v139
v_add_f32 v128, v128, v140
v_add_f32 v129, v129, v141
v_add_f32 v130, v130, v142
v_add_f32 v131, v131, v143
v_add_f32 v128, v128, v144
v_add_f32 v129, v129, v145
v_add_f32 v130, v130, v146
v_add_f32 v131, v131, v147
v_add_f32 v128, v128, v148
v_add_f32 v129, v129, v149
v_add_f32 v130, v130, v150
v_add_f32 v131, v131, v151
v_add_f32 v128, v128, v152
v_add_f32 v129, v129, v153
v_add_f32 v130, v130, v154
v_add_f32 v131, v131, v155
v_add_f32 v128, v128, v156
v_add_f32 v129, v129, v157
v_add_f32 v130, v130, v158
v_add_f32 v131, v131, v159
v_add_f32 v128, v128, v160
v_add_f32 v129, v129, v161
v_add_f32 v130, v130, v162
v_add_f32 v131, v131, v163
v_mov_b32 v9, v128
s_nop 1
v_permlane32_swap_b32 v9, v128
v_add_f32 v128, v128, v9
v_cvt_pk_bf16_f32 v128, v128, v128
v_lshlrev_b32 v128, 16, v128
v_mov_b32 v9, v129
s_nop 1
v_permlane32_swap_b32 v9, v129
v_add_f32 v129, v129, v9
v_cvt_pk_bf16_f32 v129, v129, v129
v_lshlrev_b32 v129, 16, v129
v_mov_b32 v9, v130
s_nop 1
v_permlane32_swap_b32 v9, v130
v_add_f32 v130, v130, v9
v_cvt_pk_bf16_f32 v130, v130, v130
v_lshlrev_b32 v130, 16, v130
v_mov_b32 v9, v131
s_nop 1
v_permlane32_swap_b32 v9, v131
v_add_f32 v131, v131, v9
v_cvt_pk_bf16_f32 v131, v131, v131
v_lshlrev_b32 v131, 16, v131
v_bfe_u32 v9, v0, 4, 1
v_mul_u32_u24 v9, 1152, v9
v_and_b32 v10, 15, v0
v_lshl_add_u32 v136, v10, 3, v9
buffer_load_dwordx2 v[138:139], v136, s[48:51], s81 offen
s_waitcnt vmcnt(0)
v_lshlrev_b32 v132, 16, v138
v_and_b32 v133, 0xffff0000, v138
v_lshlrev_b32 v134, 16, v139
v_and_b32 v135, 0xffff0000, v139
s_mov_b32 exec_hi, 0
ds_write_b128 v6, v[128:131] offset:2816
ds_write_b128 v6, v[132:135] offset:3328
v_mov_b32 v9, 1
s_waitcnt lgkmcnt(0)
ds_write_b32 v8, v9 offset:9048
s_mov_b64 exec, -1
L_end:
s_endpgm
.section .rodata,"a"
.p2align 6
.amdhsa_kernel parallel_sum__gqa_block_cached__geglu_ffn__decode_kernel
  .amdhsa_next_free_vgpr 256
  .amdhsa_next_free_sgpr 102
  .amdhsa_accum_offset 256
  .amdhsa_group_segment_fixed_size 0
  .amdhsa_kernarg_size 96
  .amdhsa_user_sgpr_count 2
  .amdhsa_user_sgpr_kernarg_segment_ptr 1
  .amdhsa_system_sgpr_workgroup_id_x 1
  .amdhsa_float_denorm_mode_32 3
.end_amdhsa_kernel
```
